```python
import torch

def _softmax(x, axis=-1):
    return torch.softmax(x, dim=axis)
def _gelu(x):
    return torch.nn.functional.gelu(x, approximate="tanh")
def _silu(x):
    return torch.nn.functional.silu(x)
def _sigmoid(x):
    return torch.sigmoid(x)
def _layernorm(x, axis=-1, eps=1e-5):
    m = x.mean(dim=axis, keepdim=True)
    v = x.var(dim=axis, keepdim=True, unbiased=False)
    return (x - m) / torch.sqrt(v + eps)
def _scatter_add(tgt, idx, src, axis=0):
    return tgt.clone().index_add_(axis, idx, src)
def _segment_sum(src, seg, n):
    out = torch.zeros((n,) + src.shape[1:], dtype=src.dtype)
    return out.index_add_(0, seg, src)
def _pad(x, pw):
    flat = tuple(v for pair in reversed(pw) for v in pair)
    return torch.nn.functional.pad(x, flat)

kernel_name = 'sequential_preLN__mha_block_cached__swiglu_ffn__decode'

def setup_inputs():

    _w = (lambda a: (lambda t: t.to(torch.bfloat16) if t.is_floating_point() else t)(torch.as_tensor(a)))
    def _A_setup():
        B, Sq, D = 8, 1, 512
        H, Sk, Dh = 32, 4096, 128
        return {
            "x": _w((lambda *s: torch.randn(*s, dtype=torch.bfloat16) * 0.05)(B, Sq, D)),
            "k_cache": _w((lambda *s: torch.randn(*s, dtype=torch.bfloat16) * 3.2)(B, H, Sk, Dh)),
            "v_cache": _w((lambda *s: torch.randn(*s, dtype=torch.bfloat16) * 0.4)(B, H, Sk, Dh)),
            "wq": _w((lambda *s: torch.randn(*s, dtype=torch.bfloat16) * 3.2)(D, H * Dh) * (D ** -0.5)),
            "wo": _w((lambda *s: torch.randn(*s, dtype=torch.bfloat16) * 0.4)(H * Dh, D) * ((H * Dh) ** -0.5)),
        }
    _A_in = _A_setup()

    def _B_setup():
        B, S, D, F = 8, 1, 512, 1376
        return {
            "x": _w((lambda *s: torch.randn(*s, dtype=torch.bfloat16) * 0.05)(B, S, D)),
            "w_gate": _w((lambda *s: torch.randn(*s, dtype=torch.bfloat16) * 0.05)(D, F)),
            "w_up": _w((lambda *s: torch.randn(*s, dtype=torch.bfloat16) * 0.05)(D, F)),
            "w_down": _w((lambda *s: torch.randn(*s, dtype=torch.bfloat16) * 0.05)(F, D)),
        }
    _B_in = _B_setup()

    return {
        "A_x": _A_in["x"],
        "A_k_cache": _A_in["k_cache"],
        "A_v_cache": _A_in["v_cache"],
        "A_wq": _A_in["wq"],
        "A_wo": _A_in["wo"],
        "B_x": _B_in["x"],
        "B_w_gate": _B_in["w_gate"],
        "B_w_up": _B_in["w_up"],
        "B_w_down": _B_in["w_down"],
    }

def reference(A_x, A_k_cache, A_v_cache, A_wq, A_wo, B_x, B_w_gate, B_w_up, B_w_down):
    def _A_ref(x, k_cache, v_cache, wq, wo):
        B, Sq, D = x.shape
        H, Dh = 32, 128
        q = (lambda x, *d: x.permute(*d))((x @ wq).reshape(B, Sq, H, Dh), 0, 2, 1, 3)
        scores = torch.einsum("bhqd,bhkd->bhqk", q, k_cache) * (Dh ** -0.5)
        p = _softmax(scores, axis=-1)
        o = torch.einsum("bhqk,bhkd->bhqd", p, v_cache)
        return (lambda x, *d: x.permute(*d))(o, 0, 2, 1, 3).reshape(B, Sq, H * Dh) @ wo

    def _B_ref(x, w_gate, w_up, w_down):
        g = _silu(x @ w_gate)
        u = x @ w_up
        return (g * u) @ w_down

    x = A_x
    h = x + _A_ref(_layernorm(x, axis=-1), A_k_cache, A_v_cache, A_wq, A_wo)
    h2 = h + _B_ref(_layernorm(h, axis=-1), B_w_gate, B_w_up, B_w_down)
    return h2
```

```asm
; @launch grid=(256,1,1) block=(1024,1,1) lds=148480
.amdgcn_target "amdgcn-amd-amdhsa--gfx950"
.text
.globl sequential_preLN__mha_block_cached__swiglu_ffn__decode_kernel
.p2align 8
.type sequential_preLN__mha_block_cached__swiglu_ffn__decode_kernel,@function
sequential_preLN__mha_block_cached__swiglu_ffn__decode_kernel:
  s_cmp_ge_u32 s2, 256
  s_cbranch_scc1 L_end
  s_load_dwordx4 s[4:7], s[0:1], 0
  s_load_dwordx4 s[8:11], s[0:1], 16
  s_load_dwordx2 s[12:13], s[0:1], 32
  s_load_dwordx4 s[16:19], s[0:1], 80
  v_lshrrev_b32 v5, 6, v0
  v_and_b32 v1, 63, v0
  v_and_b32 v2, 15, v0
  v_bfe_u32 v3, v0, 4, 2
  v_readfirstlane_b32 s20, v5
  s_and_b32 s21, s2, 31
  s_lshr_b32 s22, s2, 5
  s_mov_b32 s64, 0x00010001
  s_mov_b32 s65, 0x00010001
  s_lshl_b64 s[66:67], s[64:65], 1
  s_lshl_b64 s[68:69], s[64:65], 2
  s_lshl_b64 s[70:71], s[64:65], 3
  s_lshl_b64 s[72:73], s[64:65], 4
  s_lshl_b64 s[74:75], s[64:65], 5
  s_lshl_b64 s[76:77], s[64:65], 6
  s_lshl_b64 s[78:79], s[64:65], 7
  s_lshl_b64 s[80:81], s[64:65], 8
  s_lshl_b64 s[82:83], s[64:65], 9
  s_lshl_b64 s[84:85], s[64:65], 10
  s_lshl_b64 s[86:87], s[64:65], 11
  s_lshl_b64 s[88:89], s[64:65], 12
  s_lshl_b64 s[90:91], s[64:65], 13
  s_lshl_b64 s[92:93], s[64:65], 14
  s_lshl_b64 s[94:95], s[64:65], 15
  s_mul_i32 s23, s2, 5
  s_mul_i32 s56, s20, 4
  s_add_u32 s23, s23, s56
  s_lshl_b32 s23, s23, 10
  v_lshlrev_b32 v5, 4, v1
  s_lshl_b32 s56, s20, 16
  v_add_u32 v4, s56, v5
  s_lshl_b32 s56, s20, 18
  v_lshlrev_b32 v6, 13, v3
  v_lshlrev_b32 v7, 4, v2
  v_add3_u32 v6, v6, v7, s56
  s_waitcnt lgkmcnt(0)
  s_lshl_b32 s56, s22, 10
  s_add_u32 s40, s4, s56
  s_addc_u32 s41, s5, 0
  s_and_b32 s41, s41, 0xffff
  s_mov_b32 s42, 1024
  s_mov_b32 s43, 0x00020000
  s_lshl_b32 s56, s21, 8
  s_sub_u32 s57, 0x400000, s56
  s_add_u32 s32, s10, s56
  s_addc_u32 s33, s11, 0
  s_and_b32 s33, s33, 0xffff
  s_mov_b32 s34, s57
  s_mov_b32 s35, 0x00020000
  s_lshl_b32 s56, s2, 20
  s_add_u32 s24, s6, s56
  s_addc_u32 s25, s7, 0
  s_and_b32 s25, s25, 0xffff
  s_mov_b32 s26, 1048576
  s_mov_b32 s27, 0x00020000
  s_add_u32 s28, s8, s56
  s_addc_u32 s29, s9, 0
  s_and_b32 s29, s29, 0xffff
  s_mov_b32 s30, 1048576
  s_mov_b32 s31, 0x00020000
  s_lshl_b32 s56, s21, 17
  s_add_u32 s36, s12, s56
  s_addc_u32 s37, s13, 0
  s_and_b32 s37, s37, 0xffff
  s_mov_b32 s38, 131072
  s_mov_b32 s39, 0x00020000
  s_mov_b32 s44, s18
  s_and_b32 s45, s19, 0xffff
  s_mov_b32 s46, 2097152
  s_mov_b32 s47, 0x00020000
  s_mov_b32 s48, s16
  s_and_b32 s49, s17, 0xffff
  s_mov_b32 s50, 256
  s_mov_b32 s51, 0x00020000
  s_lshl_b32 s56, s2, 4
  s_add_u32 s56, s56, s20
  s_cmp_lg_u32 s56, 15
  s_cbranch_scc1 L_nozero
  v_mov_b32 v8, 0
  v_mov_b32 v9, 0
  v_mov_b32 v10, 0
  v_mov_b32 v11, 0
  s_mov_b32 s57, 0
  buffer_store_dwordx4 v[8:11], v5, s[44:47], s57 offen sc1
  buffer_store_dwordx4 v[8:11], v5, s[44:47], s57 offen offset:1024 sc1
  buffer_store_dwordx4 v[8:11], v5, s[44:47], s57 offen offset:2048 sc1
  buffer_store_dwordx4 v[8:11], v5, s[44:47], s57 offen offset:3072 sc1
  s_mov_b32 s57, 4096
  buffer_store_dwordx4 v[8:11], v5, s[44:47], s57 offen sc1
  buffer_store_dwordx4 v[8:11], v5, s[44:47], s57 offen offset:1024 sc1
  buffer_store_dwordx4 v[8:11], v5, s[44:47], s57 offen offset:2048 sc1
  buffer_store_dwordx4 v[8:11], v5, s[44:47], s57 offen offset:3072 sc1
  s_mov_b32 s57, 8192
  buffer_store_dwordx4 v[8:11], v5, s[44:47], s57 offen sc1
  buffer_store_dwordx4 v[8:11], v5, s[44:47], s57 offen offset:1024 sc1
  buffer_store_dwordx4 v[8:11], v5, s[44:47], s57 offen offset:2048 sc1
  buffer_store_dwordx4 v[8:11], v5, s[44:47], s57 offen offset:3072 sc1
  s_mov_b32 s57, 12288
  buffer_store_dwordx4 v[8:11], v5, s[44:47], s57 offen sc1
  buffer_store_dwordx4 v[8:11], v5, s[44:47], s57 offen offset:1024 sc1
  buffer_store_dwordx4 v[8:11], v5, s[44:47], s57 offen offset:2048 sc1
  buffer_store_dwordx4 v[8:11], v5, s[44:47], s57 offen offset:3072 sc1
  s_mov_b32 s57, 16384
  buffer_store_dwordx4 v[8:11], v5, s[44:47], s57 offen sc1
  buffer_store_dwordx4 v[8:11], v5, s[44:47], s57 offen offset:1024 sc1
  buffer_store_dwordx4 v[8:11], v5, s[44:47], s57 offen offset:2048 sc1
  buffer_store_dwordx4 v[8:11], v5, s[44:47], s57 offen offset:3072 sc1
  s_mov_b32 s57, 20480
  buffer_store_dwordx4 v[8:11], v5, s[44:47], s57 offen sc1
  buffer_store_dwordx4 v[8:11], v5, s[44:47], s57 offen offset:1024 sc1
  buffer_store_dwordx4 v[8:11], v5, s[44:47], s57 offen offset:2048 sc1
  buffer_store_dwordx4 v[8:11], v5, s[44:47], s57 offen offset:3072 sc1
  s_mov_b32 s57, 24576
  buffer_store_dwordx4 v[8:11], v5, s[44:47], s57 offen sc1
  buffer_store_dwordx4 v[8:11], v5, s[44:47], s57 offen offset:1024 sc1
  buffer_store_dwordx4 v[8:11], v5, s[44:47], s57 offen offset:2048 sc1
  buffer_store_dwordx4 v[8:11], v5, s[44:47], s57 offen offset:3072 sc1
  s_mov_b32 s57, 28672
  buffer_store_dwordx4 v[8:11], v5, s[44:47], s57 offen sc1
  buffer_store_dwordx4 v[8:11], v5, s[44:47], s57 offen offset:1024 sc1
  buffer_store_dwordx4 v[8:11], v5, s[44:47], s57 offen offset:2048 sc1
  buffer_store_dwordx4 v[8:11], v5, s[44:47], s57 offen offset:3072 sc1
  s_waitcnt vmcnt(0)
  v_mov_b32 v9, 1
  s_mov_b64 s[62:63], exec
  s_mov_b64 exec, 1
  buffer_atomic_add v9, v8, s[48:51], 0 offen offset:128
  s_mov_b64 exec, s[62:63]
  s_waitcnt vmcnt(0)
L_nozero:
  buffer_load_dwordx4 v[24:27], v5, s[40:43], 0 offen
  s_mov_b32 s57, 0
  buffer_load_dwordx4 v[32:35], v6, s[32:35], s57 offen
  s_mov_b32 s57, 32768
  buffer_load_dwordx4 v[36:39], v6, s[32:35], s57 offen
  s_mov_b32 s57, 65536
  buffer_load_dwordx4 v[40:43], v6, s[32:35], s57 offen
  s_mov_b32 s57, 98304
  buffer_load_dwordx4 v[44:47], v6, s[32:35], s57 offen
  s_mov_b32 s57, 131072
  buffer_load_dwordx4 v[48:51], v6, s[32:35], s57 offen
  s_mov_b32 s57, 163840
  buffer_load_dwordx4 v[52:55], v6, s[32:35], s57 offen
  s_mov_b32 s57, 196608
  buffer_load_dwordx4 v[56:59], v6, s[32:35], s57 offen
  s_mov_b32 s57, 229376
  buffer_load_dwordx4 v[60:63], v6, s[32:35], s57 offen
  s_add_u32 s58, s23, 0
  s_and_b32 s58, s58, 0xffff
  buffer_load_dwordx4 v[64:67], v4, s[24:27], s58 offen nt
  s_add_u32 s58, s23, 1024
  s_and_b32 s58, s58, 0xffff
  buffer_load_dwordx4 v[68:71], v4, s[24:27], s58 offen nt
  s_add_u32 s58, s23, 2048
  s_and_b32 s58, s58, 0xffff
  buffer_load_dwordx4 v[72:75], v4, s[24:27], s58 offen nt
  s_add_u32 s58, s23, 3072
  s_and_b32 s58, s58, 0xffff
  buffer_load_dwordx4 v[76:79], v4, s[24:27], s58 offen nt
  s_add_u32 s58, s23, 4096
  s_and_b32 s58, s58, 0xffff
  buffer_load_dwordx4 v[80:83], v4, s[24:27], s58 offen nt
  s_add_u32 s58, s23, 5120
  s_and_b32 s58, s58, 0xffff
  buffer_load_dwordx4 v[84:87], v4, s[24:27], s58 offen nt
  s_add_u32 s58, s23, 6144
  s_and_b32 s58, s58, 0xffff
  buffer_load_dwordx4 v[88:91], v4, s[24:27], s58 offen nt
  s_add_u32 s58, s23, 7168
  s_and_b32 s58, s58, 0xffff
  buffer_load_dwordx4 v[92:95], v4, s[24:27], s58 offen nt
  s_add_u32 s58, s23, 8192
  s_and_b32 s58, s58, 0xffff
  buffer_load_dwordx4 v[96:99], v4, s[24:27], s58 offen nt
  s_add_u32 s58, s23, 9216
  s_and_b32 s58, s58, 0xffff
  buffer_load_dwordx4 v[100:103], v4, s[24:27], s58 offen nt
  s_add_u32 s58, s23, 10240
  s_and_b32 s58, s58, 0xffff
  buffer_load_dwordx4 v[104:107], v4, s[24:27], s58 offen nt
  s_add_u32 s58, s23, 11264
  s_and_b32 s58, s58, 0xffff
  buffer_load_dwordx4 v[108:111], v4, s[24:27], s58 offen nt
  s_add_u32 s58, s23, 12288
  s_and_b32 s58, s58, 0xffff
  buffer_load_dwordx4 v[112:115], v4, s[24:27], s58 offen nt
  s_add_u32 s58, s23, 13312
  s_and_b32 s58, s58, 0xffff
  buffer_load_dwordx4 v[116:119], v4, s[24:27], s58 offen nt
  s_add_u32 s58, s23, 14336
  s_and_b32 s58, s58, 0xffff
  buffer_load_dwordx4 v[120:123], v4, s[24:27], s58 offen nt
  s_add_u32 s58, s23, 15360
  s_and_b32 s58, s58, 0xffff
  buffer_load_dwordx4 v[124:127], v4, s[24:27], s58 offen nt
  s_waitcnt vmcnt(24)
  v_lshlrev_b32 v16, 16, v24
  v_and_b32 v17, 0xffff0000, v24
  v_lshlrev_b32 v18, 16, v25
  v_and_b32 v19, 0xffff0000, v25
  v_lshlrev_b32 v20, 16, v26
  v_and_b32 v21, 0xffff0000, v26
  v_lshlrev_b32 v22, 16, v27
  v_and_b32 v23, 0xffff0000, v27
  v_add_f32 v24, v16, v17
  v_add_f32 v25, v18, v19
  v_add_f32 v26, v20, v21
  v_add_f32 v27, v22, v23
  v_add_f32 v24, v24, v25
  v_add_f32 v26, v26, v27
  v_add_f32 v24, v24, v26
  s_nop 1
  v_add_f32_dpp v24, v24, v24 row_ror:8 row_mask:0xf bank_mask:0xf
  s_nop 1
  v_add_f32_dpp v24, v24, v24 row_ror:4 row_mask:0xf bank_mask:0xf
  s_nop 1
  v_add_f32_dpp v24, v24, v24 row_ror:2 row_mask:0xf bank_mask:0xf
  s_nop 1
  v_add_f32_dpp v24, v24, v24 row_ror:1 row_mask:0xf bank_mask:0xf
  s_nop 1
  v_add_f32_dpp v24, v24, v24 row_bcast:15 row_mask:0xa bank_mask:0xf
  s_nop 1
  v_add_f32_dpp v24, v24, v24 row_bcast:31 row_mask:0xc bank_mask:0xf
  s_nop 0
  v_readlane_b32 s60, v24, 63
  s_nop 1
  v_mov_b32 v28, s60
  v_mul_f32 v28, 0x3b000000, v28
  v_sub_f32 v24, v16, v28
  v_mul_f32 v25, v24, v24
  v_sub_f32 v24, v17, v28
  v_fmac_f32 v25, v24, v24
  v_sub_f32 v24, v18, v28
  v_fmac_f32 v25, v24, v24
  v_sub_f32 v24, v19, v28
  v_fmac_f32 v25, v24, v24
  v_sub_f32 v24, v20, v28
  v_fmac_f32 v25, v24, v24
  v_sub_f32 v24, v21, v28
  v_fmac_f32 v25, v24, v24
  v_sub_f32 v24, v22, v28
  v_fmac_f32 v25, v24, v24
  v_sub_f32 v24, v23, v28
  v_fmac_f32 v25, v24, v24
  s_nop 1
  v_add_f32_dpp v25, v25, v25 row_ror:8 row_mask:0xf bank_mask:0xf
  s_nop 1
  v_add_f32_dpp v25, v25, v25 row_ror:4 row_mask:0xf bank_mask:0xf
  s_nop 1
  v_add_f32_dpp v25, v25, v25 row_ror:2 row_mask:0xf bank_mask:0xf
  s_nop 1
  v_add_f32_dpp v25, v25, v25 row_ror:1 row_mask:0xf bank_mask:0xf
  s_nop 1
  v_add_f32_dpp v25, v25, v25 row_bcast:15 row_mask:0xa bank_mask:0xf
  s_nop 1
  v_add_f32_dpp v25, v25, v25 row_bcast:31 row_mask:0xc bank_mask:0xf
  s_nop 0
  v_readlane_b32 s61, v25, 63
  s_nop 1
  v_mov_b32 v25, s61
  v_mul_f32 v25, 0x3b000000, v25
  v_cvt_pk_bf16_f32 v25, v25, v25
  v_and_b32 v25, 0xffff0000, v25
  v_add_f32 v25, 0x3727c5ac, v25
  v_cvt_pk_bf16_f32 v25, v25, v25
  v_and_b32 v25, 0xffff0000, v25
  v_sqrt_f32 v25, v25
  s_nop 0
  v_cvt_pk_bf16_f32 v25, v25, v25
  v_and_b32 v25, 0xffff0000, v25
  v_rcp_f32 v26, v25
  v_cvt_pk_bf16_f32 v28, v28, v28
  v_and_b32 v28, 0xffff0000, v28
  v_sub_f32 v24, v16, v28
  v_cvt_pk_bf16_f32 v24, v24, v24
  v_and_b32 v24, 0xffff0000, v24
  v_mul_f32 v27, v24, v26
  v_fma_f32 v24, -v27, v25, v24
  v_fma_f32 v16, v24, v26, v27
  v_sub_f32 v24, v17, v28
  v_cvt_pk_bf16_f32 v24, v24, v24
  v_and_b32 v24, 0xffff0000, v24
  v_mul_f32 v27, v24, v26
  v_fma_f32 v24, -v27, v25, v24
  v_fma_f32 v17, v24, v26, v27
  v_sub_f32 v24, v18, v28
  v_cvt_pk_bf16_f32 v24, v24, v24
  v_and_b32 v24, 0xffff0000, v24
  v_mul_f32 v27, v24, v26
  v_fma_f32 v24, -v27, v25, v24
  v_fma_f32 v18, v24, v26, v27
  v_sub_f32 v24, v19, v28
  v_cvt_pk_bf16_f32 v24, v24, v24
  v_and_b32 v24, 0xffff0000, v24
  v_mul_f32 v27, v24, v26
  v_fma_f32 v24, -v27, v25, v24
  v_fma_f32 v19, v24, v26, v27
  v_sub_f32 v24, v20, v28
  v_cvt_pk_bf16_f32 v24, v24, v24
  v_and_b32 v24, 0xffff0000, v24
  v_mul_f32 v27, v24, v26
  v_fma_f32 v24, -v27, v25, v24
  v_fma_f32 v20, v24, v26, v27
  v_sub_f32 v24, v21, v28
  v_cvt_pk_bf16_f32 v24, v24, v24
  v_and_b32 v24, 0xffff0000, v24
  v_mul_f32 v27, v24, v26
  v_fma_f32 v24, -v27, v25, v24
  v_fma_f32 v21, v24, v26, v27
  v_sub_f32 v24, v22, v28
  v_cvt_pk_bf16_f32 v24, v24, v24
  v_and_b32 v24, 0xffff0000, v24
  v_mul_f32 v27, v24, v26
  v_fma_f32 v24, -v27, v25, v24
  v_fma_f32 v22, v24, v26, v27
  v_sub_f32 v24, v23, v28
  v_cvt_pk_bf16_f32 v24, v24, v24
  v_and_b32 v24, 0xffff0000, v24
  v_mul_f32 v27, v24, v26
  v_fma_f32 v24, -v27, v25, v24
  v_fma_f32 v23, v24, v26, v27
  v_cvt_pk_bf16_f32 v8, v16, v17
  v_cvt_pk_bf16_f32 v9, v18, v19
  v_cvt_pk_bf16_f32 v10, v20, v21
  v_cvt_pk_bf16_f32 v11, v22, v23
  ds_write_b128 v5, v[8:11] offset:0
  s_lshl_b32 s56, s20, 6
  v_lshlrev_b32 v7, 1, v3
  v_add_u32 v7, s56, v7
  s_waitcnt lgkmcnt(0)
  ds_read_u16 v16, v7 offset:0
  ds_read_u16 v17, v7 offset:8
  ds_read_u16 v18, v7 offset:16
  ds_read_u16 v19, v7 offset:24
  ds_read_u16 v20, v7 offset:32
  ds_read_u16 v21, v7 offset:40
  ds_read_u16 v22, v7 offset:48
  ds_read_u16 v23, v7 offset:56
  v_mov_b32 v24, 0
  v_mov_b32 v25, 0
  v_mov_b32 v26, 0
  v_mov_b32 v27, 0
  v_mov_b32 v28, 0
  v_mov_b32 v29, 0
  v_mov_b32 v30, 0
  v_mov_b32 v31, 0
  s_waitcnt lgkmcnt(0)
  v_lshlrev_b32 v8, 16, v16
  v_lshlrev_b32 v9, 16, v17
  v_lshlrev_b32 v10, 16, v18
  v_lshlrev_b32 v11, 16, v19
  v_lshlrev_b32 v12, 16, v20
  v_lshlrev_b32 v13, 16, v21
  v_lshlrev_b32 v14, 16, v22
  v_lshlrev_b32 v15, 16, v23
  s_waitcnt vmcnt(16)
  v_dot2c_f32_bf16 v24, v16, v32
  v_dot2c_f32_bf16 v25, v8, v32
  v_dot2c_f32_bf16 v26, v16, v33
  v_dot2c_f32_bf16 v27, v8, v33
  v_dot2c_f32_bf16 v28, v16, v34
  v_dot2c_f32_bf16 v29, v8, v34
  v_dot2c_f32_bf16 v30, v16, v35
  v_dot2c_f32_bf16 v31, v8, v35
  v_dot2c_f32_bf16 v24, v17, v36
  v_dot2c_f32_bf16 v25, v9, v36
  v_dot2c_f32_bf16 v26, v17, v37
  v_dot2c_f32_bf16 v27, v9, v37
  v_dot2c_f32_bf16 v28, v17, v38
  v_dot2c_f32_bf16 v29, v9, v38
  v_dot2c_f32_bf16 v30, v17, v39
  v_dot2c_f32_bf16 v31, v9, v39
  v_dot2c_f32_bf16 v24, v18, v40
  v_dot2c_f32_bf16 v25, v10, v40
  v_dot2c_f32_bf16 v26, v18, v41
  v_dot2c_f32_bf16 v27, v10, v41
  v_dot2c_f32_bf16 v28, v18, v42
  v_dot2c_f32_bf16 v29, v10, v42
  v_dot2c_f32_bf16 v30, v18, v43
  v_dot2c_f32_bf16 v31, v10, v43
  v_dot2c_f32_bf16 v24, v19, v44
  v_dot2c_f32_bf16 v25, v11, v44
  v_dot2c_f32_bf16 v26, v19, v45
  v_dot2c_f32_bf16 v27, v11, v45
  v_dot2c_f32_bf16 v28, v19, v46
  v_dot2c_f32_bf16 v29, v11, v46
  v_dot2c_f32_bf16 v30, v19, v47
  v_dot2c_f32_bf16 v31, v11, v47
  v_dot2c_f32_bf16 v24, v20, v48
  v_dot2c_f32_bf16 v25, v12, v48
  v_dot2c_f32_bf16 v26, v20, v49
  v_dot2c_f32_bf16 v27, v12, v49
  v_dot2c_f32_bf16 v28, v20, v50
  v_dot2c_f32_bf16 v29, v12, v50
  v_dot2c_f32_bf16 v30, v20, v51
  v_dot2c_f32_bf16 v31, v12, v51
  v_dot2c_f32_bf16 v24, v21, v52
  v_dot2c_f32_bf16 v25, v13, v52
  v_dot2c_f32_bf16 v26, v21, v53
  v_dot2c_f32_bf16 v27, v13, v53
  v_dot2c_f32_bf16 v28, v21, v54
  v_dot2c_f32_bf16 v29, v13, v54
  v_dot2c_f32_bf16 v30, v21, v55
  v_dot2c_f32_bf16 v31, v13, v55
  v_dot2c_f32_bf16 v24, v22, v56
  v_dot2c_f32_bf16 v25, v14, v56
  v_dot2c_f32_bf16 v26, v22, v57
  v_dot2c_f32_bf16 v27, v14, v57
  v_dot2c_f32_bf16 v28, v22, v58
  v_dot2c_f32_bf16 v29, v14, v58
  v_dot2c_f32_bf16 v30, v22, v59
  v_dot2c_f32_bf16 v31, v14, v59
  v_dot2c_f32_bf16 v24, v23, v60
  v_dot2c_f32_bf16 v25, v15, v60
  v_dot2c_f32_bf16 v26, v23, v61
  v_dot2c_f32_bf16 v27, v15, v61
  v_dot2c_f32_bf16 v28, v23, v62
  v_dot2c_f32_bf16 v29, v15, v62
  v_dot2c_f32_bf16 v30, v23, v63
  v_dot2c_f32_bf16 v31, v15, v63
  s_nop 2
  v_mov_b32 v16, v24
  v_mov_b32 v17, v25
  v_mov_b32 v18, v26
  v_mov_b32 v19, v27
  v_mov_b32 v20, v28
  v_mov_b32 v21, v29
  v_mov_b32 v22, v30
  v_mov_b32 v23, v31
  s_nop 1
  v_permlane32_swap_b32 v16, v24
  v_permlane32_swap_b32 v17, v25
  v_permlane32_swap_b32 v18, v26
  v_permlane32_swap_b32 v19, v27
  v_permlane32_swap_b32 v20, v28
  v_permlane32_swap_b32 v21, v29
  v_permlane32_swap_b32 v22, v30
  v_permlane32_swap_b32 v23, v31
  v_add_f32 v24, v16, v24
  v_add_f32 v25, v17, v25
  v_add_f32 v26, v18, v26
  v_add_f32 v27, v19, v27
  v_add_f32 v28, v20, v28
  v_add_f32 v29, v21, v29
  v_add_f32 v30, v22, v30
  v_add_f32 v31, v23, v31
  v_mov_b32 v16, v24
  v_mov_b32 v17, v25
  v_mov_b32 v18, v26
  v_mov_b32 v19, v27
  v_mov_b32 v20, v28
  v_mov_b32 v21, v29
  v_mov_b32 v22, v30
  v_mov_b32 v23, v31
  s_nop 1
  v_permlane16_swap_b32 v16, v24
  v_permlane16_swap_b32 v17, v25
  v_permlane16_swap_b32 v18, v26
  v_permlane16_swap_b32 v19, v27
  v_permlane16_swap_b32 v20, v28
  v_permlane16_swap_b32 v21, v29
  v_permlane16_swap_b32 v22, v30
  v_permlane16_swap_b32 v23, v31
  v_add_f32 v24, v16, v24
  v_add_f32 v25, v17, v25
  v_add_f32 v26, v18, v26
  v_add_f32 v27, v19, v27
  v_add_f32 v28, v20, v28
  v_add_f32 v29, v21, v29
  v_add_f32 v30, v22, v30
  v_add_f32 v31, v23, v31
  s_lshl_b32 s56, s20, 9
  v_lshlrev_b32 v7, 5, v2
  v_add_u32 v6, s56, v7
  ds_write_b128 v6, v[24:27] offset:1024
  ds_write_b128 v6, v[28:31] offset:1040
  v_lshl_add_u32 v6, v3, 11, v7
  s_waitcnt lgkmcnt(0)
  s_barrier
  ds_read_b128 v[32:35], v6 offset:1024
  ds_read_b128 v[36:39], v6 offset:1040
  ds_read_b128 v[40:43], v6 offset:1536
  ds_read_b128 v[44:47], v6 offset:1552
  ds_read_b128 v[48:51], v6 offset:2048
  ds_read_b128 v[52:55], v6 offset:2064
  ds_read_b128 v[56:59], v6 offset:2560
  ds_read_b128 v[60:63], v6 offset:2576
  s_waitcnt lgkmcnt(0)
  v_add_f32 v32, v32, v40
  v_add_f32 v48, v48, v56
  v_add_f32 v33, v33, v41
  v_add_f32 v49, v49, v57
  v_add_f32 v34, v34, v42
  v_add_f32 v50, v50, v58
  v_add_f32 v35, v35, v43
  v_add_f32 v51, v51, v59
  v_add_f32 v36, v36, v44
  v_add_f32 v52, v52, v60
  v_add_f32 v37, v37, v45
  v_add_f32 v53, v53, v61
  v_add_f32 v38, v38, v46
  v_add_f32 v54, v54, v62
  v_add_f32 v39, v39, v47
  v_add_f32 v55, v55, v63
  v_add_f32 v32, v32, v48
  v_add_f32 v33, v33, v49
  v_add_f32 v34, v34, v50
  v_add_f32 v35, v35, v51
  v_add_f32 v36, v36, v52
  v_add_f32 v37, v37, v53
  v_add_f32 v38, v38, v54
  v_add_f32 v39, v39, v55
  v_mov_b32 v40, v32
  v_mov_b32 v41, v33
  v_mov_b32 v42, v34
  v_mov_b32 v43, v35
  v_mov_b32 v44, v36
  v_mov_b32 v45, v37
  v_mov_b32 v46, v38
  v_mov_b32 v47, v39
  s_nop 1
  v_permlane32_swap_b32 v40, v32
  v_permlane32_swap_b32 v41, v33
  v_permlane32_swap_b32 v42, v34
  v_permlane32_swap_b32 v43, v35
  v_permlane32_swap_b32 v44, v36
  v_permlane32_swap_b32 v45, v37
  v_permlane32_swap_b32 v46, v38
  v_permlane32_swap_b32 v47, v39
  v_add_f32 v32, v40, v32
  v_add_f32 v33, v41, v33
  v_add_f32 v34, v42, v34
  v_add_f32 v35, v43, v35
  v_add_f32 v36, v44, v36
  v_add_f32 v37, v45, v37
  v_add_f32 v38, v46, v38
  v_add_f32 v39, v47, v39
  v_mov_b32 v40, v32
  v_mov_b32 v41, v33
  v_mov_b32 v42, v34
  v_mov_b32 v43, v35
  v_mov_b32 v44, v36
  v_mov_b32 v45, v37
  v_mov_b32 v46, v38
  v_mov_b32 v47, v39
  s_nop 1
  v_permlane16_swap_b32 v40, v32
  v_permlane16_swap_b32 v41, v33
  v_permlane16_swap_b32 v42, v34
  v_permlane16_swap_b32 v43, v35
  v_permlane16_swap_b32 v44, v36
  v_permlane16_swap_b32 v45, v37
  v_permlane16_swap_b32 v46, v38
  v_permlane16_swap_b32 v47, v39
  v_add_f32 v32, v40, v32
  v_add_f32 v33, v41, v33
  v_add_f32 v34, v42, v34
  v_add_f32 v35, v43, v35
  v_add_f32 v36, v44, v36
  v_add_f32 v37, v45, v37
  v_add_f32 v38, v46, v38
  v_add_f32 v39, v47, v39
  v_cvt_pk_bf16_f32 v8, v32, v33
  v_cvt_pk_bf16_f32 v9, v34, v35
  v_cvt_pk_bf16_f32 v10, v36, v37
  v_cvt_pk_bf16_f32 v11, v38, v39
  v_mov_b32 v12, 0
  v_mov_b32 v13, 0
  v_mov_b32 v14, 0
  v_mov_b32 v15, 0
  s_lshl_b32 s59, s20, 13
  buffer_load_dwordx4 v[32:35], v5, s[36:39], s59 offen
  buffer_load_dwordx4 v[36:39], v5, s[36:39], s59 offen offset:1024
  buffer_load_dwordx4 v[40:43], v5, s[36:39], s59 offen offset:2048
  buffer_load_dwordx4 v[44:47], v5, s[36:39], s59 offen offset:3072
  s_add_u32 s59, s59, 4096
  buffer_load_dwordx4 v[48:51], v5, s[36:39], s59 offen
  buffer_load_dwordx4 v[52:55], v5, s[36:39], s59 offen offset:1024
  buffer_load_dwordx4 v[56:59], v5, s[36:39], s59 offen offset:2048
  buffer_load_dwordx4 v[60:63], v5, s[36:39], s59 offen offset:3072
  s_waitcnt vmcnt(20)
  v_dot2_f32_bf16 v16, v64, v8, 0
  v_dot2_f32_bf16 v17, v68, v8, 0
  v_dot2_f32_bf16 v18, v72, v8, 0
  v_dot2_f32_bf16 v19, v76, v8, 0
  v_dot2_f32_bf16 v16, v65, v9, v16
  v_dot2_f32_bf16 v17, v69, v9, v17
  v_dot2_f32_bf16 v18, v73, v9, v18
  v_dot2_f32_bf16 v19, v77, v9, v19
  v_dot2_f32_bf16 v16, v66, v10, v16
  v_dot2_f32_bf16 v17, v70, v10, v17
  v_dot2_f32_bf16 v18, v74, v10, v18
  v_dot2_f32_bf16 v19, v78, v10, v19
  v_dot2_f32_bf16 v16, v67, v11, v16
  v_dot2_f32_bf16 v17, v71, v11, v17
  v_dot2_f32_bf16 v18, v75, v11, v18
  v_dot2_f32_bf16 v19, v79, v11, v19
  s_add_u32 s58, s23, 16384
  s_and_b32 s58, s58, 0xffff
  buffer_load_dwordx4 v[64:67], v4, s[24:27], s58 offen nt
  s_add_u32 s58, s23, 17408
  s_and_b32 s58, s58, 0xffff
  buffer_load_dwordx4 v[68:71], v4, s[24:27], s58 offen nt
  s_add_u32 s58, s23, 18432
  s_and_b32 s58, s58, 0xffff
  buffer_load_dwordx4 v[72:75], v4, s[24:27], s58 offen nt
  s_add_u32 s58, s23, 19456
  s_and_b32 s58, s58, 0xffff
  buffer_load_dwordx4 v[76:79], v4, s[24:27], s58 offen nt
  v_add_f32_dpp v16, v16, v16 row_ror:8 row_mask:0xf bank_mask:0xf
  v_add_f32_dpp v17, v17, v17 row_ror:8 row_mask:0xf bank_mask:0xf
  v_add_f32_dpp v18, v18, v18 row_ror:8 row_mask:0xf bank_mask:0xf
  v_add_f32_dpp v19, v19, v19 row_ror:8 row_mask:0xf bank_mask:0xf
  v_add_f32_dpp v16, v16, v16 row_ror:4 row_mask:0xf bank_mask:0xf
  v_add_f32_dpp v17, v17, v17 row_ror:4 row_mask:0xf bank_mask:0xf
  v_add_f32_dpp v18, v18, v18 row_ror:4 row_mask:0xf bank_mask:0xf
  v_add_f32_dpp v19, v19, v19 row_ror:4 row_mask:0xf bank_mask:0xf
  v_add_f32_dpp v16, v16, v16 row_ror:2 row_mask:0xf bank_mask:0xf
  v_add_f32_dpp v17, v17, v17 row_ror:2 row_mask:0xf bank_mask:0xf
  v_add_f32_dpp v18, v18, v18 row_ror:2 row_mask:0xf bank_mask:0xf
  v_add_f32_dpp v19, v19, v19 row_ror:2 row_mask:0xf bank_mask:0xf
  v_add_f32_dpp v16, v16, v16 row_ror:1 row_mask:0xf bank_mask:0xf
  v_add_f32_dpp v17, v17, v17 row_ror:1 row_mask:0xf bank_mask:0xf
  v_add_f32_dpp v18, v18, v18 row_ror:1 row_mask:0xf bank_mask:0xf
  v_add_f32_dpp v19, v19, v19 row_ror:1 row_mask:0xf bank_mask:0xf
  v_cndmask_b32_e64 v12, v12, v16, s[64:65]
  v_cndmask_b32_e64 v12, v12, v17, s[66:67]
  v_cndmask_b32_e64 v12, v12, v18, s[68:69]
  v_cndmask_b32_e64 v12, v12, v19, s[70:71]
  s_waitcnt vmcnt(20)
  v_dot2_f32_bf16 v16, v80, v8, 0
  v_dot2_f32_bf16 v17, v84, v8, 0
  v_dot2_f32_bf16 v18, v88, v8, 0
  v_dot2_f32_bf16 v19, v92, v8, 0
  v_dot2_f32_bf16 v16, v81, v9, v16
  v_dot2_f32_bf16 v17, v85, v9, v17
  v_dot2_f32_bf16 v18, v89, v9, v18
  v_dot2_f32_bf16 v19, v93, v9, v19
  v_dot2_f32_bf16 v16, v82, v10, v16
  v_dot2_f32_bf16 v17, v86, v10, v17
  v_dot2_f32_bf16 v18, v90, v10, v18
  v_dot2_f32_bf16 v19, v94, v10, v19
  v_dot2_f32_bf16 v16, v83, v11, v16
  v_dot2_f32_bf16 v17, v87, v11, v17
  v_dot2_f32_bf16 v18, v91, v11, v18
  v_dot2_f32_bf16 v19, v95, v11, v19
  s_add_u32 s58, s23, 20480
  s_and_b32 s58, s58, 0xffff
  buffer_load_dwordx4 v[80:83], v4, s[24:27], s58 offen nt
  s_add_u32 s58, s23, 21504
  s_and_b32 s58, s58, 0xffff
  buffer_load_dwordx4 v[84:87], v4, s[24:27], s58 offen nt
  s_add_u32 s58, s23, 22528
  s_and_b32 s58, s58, 0xffff
  buffer_load_dwordx4 v[88:91], v4, s[24:27], s58 offen nt
  s_add_u32 s58, s23, 23552
  s_and_b32 s58, s58, 0xffff
  buffer_load_dwordx4 v[92:95], v4, s[24:27], s58 offen nt
  v_add_f32_dpp v16, v16, v16 row_ror:8 row_mask:0xf bank_mask:0xf
  v_add_f32_dpp v17, v17, v17 row_ror:8 row_mask:0xf bank_mask:0xf
  v_add_f32_dpp v18, v18, v18 row_ror:8 row_mask:0xf bank_mask:0xf
  v_add_f32_dpp v19, v19, v19 row_ror:8 row_mask:0xf bank_mask:0xf
  v_add_f32_dpp v16, v16, v16 row_ror:4 row_mask:0xf bank_mask:0xf
  v_add_f32_dpp v17, v17, v17 row_ror:4 row_mask:0xf bank_mask:0xf
  v_add_f32_dpp v18, v18, v18 row_ror:4 row_mask:0xf bank_mask:0xf
  v_add_f32_dpp v19, v19, v19 row_ror:4 row_mask:0xf bank_mask:0xf
  v_add_f32_dpp v16, v16, v16 row_ror:2 row_mask:0xf bank_mask:0xf
  v_add_f32_dpp v17, v17, v17 row_ror:2 row_mask:0xf bank_mask:0xf
  v_add_f32_dpp v18, v18, v18 row_ror:2 row_mask:0xf bank_mask:0xf
  v_add_f32_dpp v19, v19, v19 row_ror:2 row_mask:0xf bank_mask:0xf
  v_add_f32_dpp v16, v16, v16 row_ror:1 row_mask:0xf bank_mask:0xf
  v_add_f32_dpp v17, v17, v17 row_ror:1 row_mask:0xf bank_mask:0xf
  v_add_f32_dpp v18, v18, v18 row_ror:1 row_mask:0xf bank_mask:0xf
  v_add_f32_dpp v19, v19, v19 row_ror:1 row_mask:0xf bank_mask:0xf
  v_cndmask_b32_e64 v12, v12, v16, s[72:73]
  v_cndmask_b32_e64 v12, v12, v17, s[74:75]
  v_cndmask_b32_e64 v12, v12, v18, s[76:77]
  v_cndmask_b32_e64 v12, v12, v19, s[78:79]
  s_waitcnt vmcnt(20)
  v_dot2_f32_bf16 v16, v96, v8, 0
  v_dot2_f32_bf16 v17, v100, v8, 0
  v_dot2_f32_bf16 v18, v104, v8, 0
  v_dot2_f32_bf16 v19, v108, v8, 0
  v_dot2_f32_bf16 v16, v97, v9, v16
  v_dot2_f32_bf16 v17, v101, v9, v17
  v_dot2_f32_bf16 v18, v105, v9, v18
  v_dot2_f32_bf16 v19, v109, v9, v19
  v_dot2_f32_bf16 v16, v98, v10, v16
  v_dot2_f32_bf16 v17, v102, v10, v17
  v_dot2_f32_bf16 v18, v106, v10, v18
  v_dot2_f32_bf16 v19, v110, v10, v19
  v_dot2_f32_bf16 v16, v99, v11, v16
  v_dot2_f32_bf16 v17, v103, v11, v17
  v_dot2_f32_bf16 v18, v107, v11, v18
  v_dot2_f32_bf16 v19, v111, v11, v19
  s_add_u32 s58, s23, 24576
  s_and_b32 s58, s58, 0xffff
  buffer_load_dwordx4 v[96:99], v4, s[24:27], s58 offen nt
  s_add_u32 s58, s23, 25600
  s_and_b32 s58, s58, 0xffff
  buffer_load_dwordx4 v[100:103], v4, s[24:27], s58 offen nt
  s_add_u32 s58, s23, 26624
  s_and_b32 s58, s58, 0xffff
  buffer_load_dwordx4 v[104:107], v4, s[24:27], s58 offen nt
  s_add_u32 s58, s23, 27648
  s_and_b32 s58, s58, 0xffff
  buffer_load_dwordx4 v[108:111], v4, s[24:27], s58 offen nt
  v_add_f32_dpp v16, v16, v16 row_ror:8 row_mask:0xf bank_mask:0xf
  v_add_f32_dpp v17, v17, v17 row_ror:8 row_mask:0xf bank_mask:0xf
  v_add_f32_dpp v18, v18, v18 row_ror:8 row_mask:0xf bank_mask:0xf
  v_add_f32_dpp v19, v19, v19 row_ror:8 row_mask:0xf bank_mask:0xf
  v_add_f32_dpp v16, v16, v16 row_ror:4 row_mask:0xf bank_mask:0xf
  v_add_f32_dpp v17, v17, v17 row_ror:4 row_mask:0xf bank_mask:0xf
  v_add_f32_dpp v18, v18, v18 row_ror:4 row_mask:0xf bank_mask:0xf
  v_add_f32_dpp v19, v19, v19 row_ror:4 row_mask:0xf bank_mask:0xf
  v_add_f32_dpp v16, v16, v16 row_ror:2 row_mask:0xf bank_mask:0xf
  v_add_f32_dpp v17, v17, v17 row_ror:2 row_mask:0xf bank_mask:0xf
  v_add_f32_dpp v18, v18, v18 row_ror:2 row_mask:0xf bank_mask:0xf
  v_add_f32_dpp v19, v19, v19 row_ror:2 row_mask:0xf bank_mask:0xf
  v_add_f32_dpp v16, v16, v16 row_ror:1 row_mask:0xf bank_mask:0xf
  v_add_f32_dpp v17, v17, v17 row_ror:1 row_mask:0xf bank_mask:0xf
  v_add_f32_dpp v18, v18, v18 row_ror:1 row_mask:0xf bank_mask:0xf
  v_add_f32_dpp v19, v19, v19 row_ror:1 row_mask:0xf bank_mask:0xf
  v_cndmask_b32_e64 v12, v12, v16, s[80:81]
  v_cndmask_b32_e64 v12, v12, v17, s[82:83]
  v_cndmask_b32_e64 v12, v12, v18, s[84:85]
  v_cndmask_b32_e64 v12, v12, v19, s[86:87]
  s_waitcnt vmcnt(20)
  v_dot2_f32_bf16 v16, v112, v8, 0
  v_dot2_f32_bf16 v17, v116, v8, 0
  v_dot2_f32_bf16 v18, v120, v8, 0
  v_dot2_f32_bf16 v19, v124, v8, 0
  v_dot2_f32_bf16 v16, v113, v9, v16
  v_dot2_f32_bf16 v17, v117, v9, v17
  v_dot2_f32_bf16 v18, v121, v9, v18
  v_dot2_f32_bf16 v19, v125, v9, v19
  v_dot2_f32_bf16 v16, v114, v10, v16
  v_dot2_f32_bf16 v17, v118, v10, v17
  v_dot2_f32_bf16 v18, v122, v10, v18
  v_dot2_f32_bf16 v19, v126, v10, v19
  v_dot2_f32_bf16 v16, v115, v11, v16
  v_dot2_f32_bf16 v17, v119, v11, v17
  v_dot2_f32_bf16 v18, v123, v11, v18
  v_dot2_f32_bf16 v19, v127, v11, v19
  s_add_u32 s58, s23, 28672
  s_and_b32 s58, s58, 0xffff
  buffer_load_dwordx4 v[112:115], v4, s[24:27], s58 offen nt
  s_add_u32 s58, s23, 29696
  s_and_b32 s58, s58, 0xffff
  buffer_load_dwordx4 v[116:119], v4, s[24:27], s58 offen nt
  s_add_u32 s58, s23, 30720
  s_and_b32 s58, s58, 0xffff
  buffer_load_dwordx4 v[120:123], v4, s[24:27], s58 offen nt
  s_add_u32 s58, s23, 31744
  s_and_b32 s58, s58, 0xffff
  buffer_load_dwordx4 v[124:127], v4, s[24:27], s58 offen nt
  v_add_f32_dpp v16, v16, v16 row_ror:8 row_mask:0xf bank_mask:0xf
  v_add_f32_dpp v17, v17, v17 row_ror:8 row_mask:0xf bank_mask:0xf
  v_add_f32_dpp v18, v18, v18 row_ror:8 row_mask:0xf bank_mask:0xf
  v_add_f32_dpp v19, v19, v19 row_ror:8 row_mask:0xf bank_mask:0xf
  v_add_f32_dpp v16, v16, v16 row_ror:4 row_mask:0xf bank_mask:0xf
  v_add_f32_dpp v17, v17, v17 row_ror:4 row_mask:0xf bank_mask:0xf
  v_add_f32_dpp v18, v18, v18 row_ror:4 row_mask:0xf bank_mask:0xf
  v_add_f32_dpp v19, v19, v19 row_ror:4 row_mask:0xf bank_mask:0xf
  v_add_f32_dpp v16, v16, v16 row_ror:2 row_mask:0xf bank_mask:0xf
  v_add_f32_dpp v17, v17, v17 row_ror:2 row_mask:0xf bank_mask:0xf
  v_add_f32_dpp v18, v18, v18 row_ror:2 row_mask:0xf bank_mask:0xf
  v_add_f32_dpp v19, v19, v19 row_ror:2 row_mask:0xf bank_mask:0xf
  v_add_f32_dpp v16, v16, v16 row_ror:1 row_mask:0xf bank_mask:0xf
  v_add_f32_dpp v17, v17, v17 row_ror:1 row_mask:0xf bank_mask:0xf
  v_add_f32_dpp v18, v18, v18 row_ror:1 row_mask:0xf bank_mask:0xf
  v_add_f32_dpp v19, v19, v19 row_ror:1 row_mask:0xf bank_mask:0xf
  v_cndmask_b32_e64 v12, v12, v16, s[88:89]
  v_cndmask_b32_e64 v12, v12, v17, s[90:91]
  v_cndmask_b32_e64 v12, v12, v18, s[92:93]
  v_cndmask_b32_e64 v12, v12, v19, s[94:95]
  s_waitcnt vmcnt(12)
  v_dot2_f32_bf16 v16, v64, v8, 0
  v_dot2_f32_bf16 v17, v68, v8, 0
  v_dot2_f32_bf16 v18, v72, v8, 0
  v_dot2_f32_bf16 v19, v76, v8, 0
  v_dot2_f32_bf16 v16, v65, v9, v16
  v_dot2_f32_bf16 v17, v69, v9, v17
  v_dot2_f32_bf16 v18, v73, v9, v18
  v_dot2_f32_bf16 v19, v77, v9, v19
  v_dot2_f32_bf16 v16, v66, v10, v16
  v_dot2_f32_bf16 v17, v70, v10, v17
  v_dot2_f32_bf16 v18, v74, v10, v18
  v_dot2_f32_bf16 v19, v78, v10, v19
  v_dot2_f32_bf16 v16, v67, v11, v16
  v_dot2_f32_bf16 v17, v71, v11, v17
  v_dot2_f32_bf16 v18, v75, v11, v18
  v_dot2_f32_bf16 v19, v79, v11, v19
  s_add_u32 s58, s23, 32768
  s_and_b32 s58, s58, 0xffff
  buffer_load_dwordx4 v[64:67], v4, s[24:27], s58 offen nt
  s_add_u32 s58, s23, 33792
  s_and_b32 s58, s58, 0xffff
  buffer_load_dwordx4 v[68:71], v4, s[24:27], s58 offen nt
  s_add_u32 s58, s23, 34816
  s_and_b32 s58, s58, 0xffff
  buffer_load_dwordx4 v[72:75], v4, s[24:27], s58 offen nt
  s_add_u32 s58, s23, 35840
  s_and_b32 s58, s58, 0xffff
  buffer_load_dwordx4 v[76:79], v4, s[24:27], s58 offen nt
  v_add_f32_dpp v16, v16, v16 row_ror:8 row_mask:0xf bank_mask:0xf
  v_add_f32_dpp v17, v17, v17 row_ror:8 row_mask:0xf bank_mask:0xf
  v_add_f32_dpp v18, v18, v18 row_ror:8 row_mask:0xf bank_mask:0xf
  v_add_f32_dpp v19, v19, v19 row_ror:8 row_mask:0xf bank_mask:0xf
  v_add_f32_dpp v16, v16, v16 row_ror:4 row_mask:0xf bank_mask:0xf
  v_add_f32_dpp v17, v17, v17 row_ror:4 row_mask:0xf bank_mask:0xf
  v_add_f32_dpp v18, v18, v18 row_ror:4 row_mask:0xf bank_mask:0xf
  v_add_f32_dpp v19, v19, v19 row_ror:4 row_mask:0xf bank_mask:0xf
  v_add_f32_dpp v16, v16, v16 row_ror:2 row_mask:0xf bank_mask:0xf
  v_add_f32_dpp v17, v17, v17 row_ror:2 row_mask:0xf bank_mask:0xf
  v_add_f32_dpp v18, v18, v18 row_ror:2 row_mask:0xf bank_mask:0xf
  v_add_f32_dpp v19, v19, v19 row_ror:2 row_mask:0xf bank_mask:0xf
  v_add_f32_dpp v16, v16, v16 row_ror:1 row_mask:0xf bank_mask:0xf
  v_add_f32_dpp v17, v17, v17 row_ror:1 row_mask:0xf bank_mask:0xf
  v_add_f32_dpp v18, v18, v18 row_ror:1 row_mask:0xf bank_mask:0xf
  v_add_f32_dpp v19, v19, v19 row_ror:1 row_mask:0xf bank_mask:0xf
  v_cndmask_b32_e64 v13, v13, v16, s[64:65]
  v_cndmask_b32_e64 v13, v13, v17, s[66:67]
  v_cndmask_b32_e64 v13, v13, v18, s[68:69]
  v_cndmask_b32_e64 v13, v13, v19, s[70:71]
  s_waitcnt vmcnt(12)
  v_dot2_f32_bf16 v16, v80, v8, 0
  v_dot2_f32_bf16 v17, v84, v8, 0
  v_dot2_f32_bf16 v18, v88, v8, 0
  v_dot2_f32_bf16 v19, v92, v8, 0
  v_dot2_f32_bf16 v16, v81, v9, v16
  v_dot2_f32_bf16 v17, v85, v9, v17
  v_dot2_f32_bf16 v18, v89, v9, v18
  v_dot2_f32_bf16 v19, v93, v9, v19
  v_dot2_f32_bf16 v16, v82, v10, v16
  v_dot2_f32_bf16 v17, v86, v10, v17
  v_dot2_f32_bf16 v18, v90, v10, v18
  v_dot2_f32_bf16 v19, v94, v10, v19
  v_dot2_f32_bf16 v16, v83, v11, v16
  v_dot2_f32_bf16 v17, v87, v11, v17
  v_dot2_f32_bf16 v18, v91, v11, v18
  v_dot2_f32_bf16 v19, v95, v11, v19
  s_add_u32 s58, s23, 36864
  s_and_b32 s58, s58, 0xffff
  buffer_load_dwordx4 v[80:83], v4, s[24:27], s58 offen nt
  s_add_u32 s58, s23, 37888
  s_and_b32 s58, s58, 0xffff
  buffer_load_dwordx4 v[84:87], v4, s[24:27], s58 offen nt
  s_add_u32 s58, s23, 38912
  s_and_b32 s58, s58, 0xffff
  buffer_load_dwordx4 v[88:91], v4, s[24:27], s58 offen nt
  s_add_u32 s58, s23, 39936
  s_and_b32 s58, s58, 0xffff
  buffer_load_dwordx4 v[92:95], v4, s[24:27], s58 offen nt
  v_add_f32_dpp v16, v16, v16 row_ror:8 row_mask:0xf bank_mask:0xf
  v_add_f32_dpp v17, v17, v17 row_ror:8 row_mask:0xf bank_mask:0xf
  v_add_f32_dpp v18, v18, v18 row_ror:8 row_mask:0xf bank_mask:0xf
  v_add_f32_dpp v19, v19, v19 row_ror:8 row_mask:0xf bank_mask:0xf
  v_add_f32_dpp v16, v16, v16 row_ror:4 row_mask:0xf bank_mask:0xf
  v_add_f32_dpp v17, v17, v17 row_ror:4 row_mask:0xf bank_mask:0xf
  v_add_f32_dpp v18, v18, v18 row_ror:4 row_mask:0xf bank_mask:0xf
  v_add_f32_dpp v19, v19, v19 row_ror:4 row_mask:0xf bank_mask:0xf
  v_add_f32_dpp v16, v16, v16 row_ror:2 row_mask:0xf bank_mask:0xf
  v_add_f32_dpp v17, v17, v17 row_ror:2 row_mask:0xf bank_mask:0xf
  v_add_f32_dpp v18, v18, v18 row_ror:2 row_mask:0xf bank_mask:0xf
  v_add_f32_dpp v19, v19, v19 row_ror:2 row_mask:0xf bank_mask:0xf
  v_add_f32_dpp v16, v16, v16 row_ror:1 row_mask:0xf bank_mask:0xf
  v_add_f32_dpp v17, v17, v17 row_ror:1 row_mask:0xf bank_mask:0xf
  v_add_f32_dpp v18, v18, v18 row_ror:1 row_mask:0xf bank_mask:0xf
  v_add_f32_dpp v19, v19, v19 row_ror:1 row_mask:0xf bank_mask:0xf
  v_cndmask_b32_e64 v13, v13, v16, s[72:73]
  v_cndmask_b32_e64 v13, v13, v17, s[74:75]
  v_cndmask_b32_e64 v13, v13, v18, s[76:77]
  v_cndmask_b32_e64 v13, v13, v19, s[78:79]
  s_waitcnt vmcnt(12)
  v_dot2_f32_bf16 v16, v96, v8, 0
  v_dot2_f32_bf16 v17, v100, v8, 0
  v_dot2_f32_bf16 v18, v104, v8, 0
  v_dot2_f32_bf16 v19, v108, v8, 0
  v_dot2_f32_bf16 v16, v97, v9, v16
  v_dot2_f32_bf16 v17, v101, v9, v17
  v_dot2_f32_bf16 v18, v105, v9, v18
  v_dot2_f32_bf16 v19, v109, v9, v19
  v_dot2_f32_bf16 v16, v98, v10, v16
  v_dot2_f32_bf16 v17, v102, v10, v17
  v_dot2_f32_bf16 v18, v106, v10, v18
  v_dot2_f32_bf16 v19, v110, v10, v19
  v_dot2_f32_bf16 v16, v99, v11, v16
  v_dot2_f32_bf16 v17, v103, v11, v17
  v_dot2_f32_bf16 v18, v107, v11, v18
  v_dot2_f32_bf16 v19, v111, v11, v19
  s_add_u32 s58, s23, 40960
  s_and_b32 s58, s58, 0xffff
  buffer_load_dwordx4 v[96:99], v4, s[24:27], s58 offen nt
  s_add_u32 s58, s23, 41984
  s_and_b32 s58, s58, 0xffff
  buffer_load_dwordx4 v[100:103], v4, s[24:27], s58 offen nt
  s_add_u32 s58, s23, 43008
  s_and_b32 s58, s58, 0xffff
  buffer_load_dwordx4 v[104:107], v4, s[24:27], s58 offen nt
  s_add_u32 s58, s23, 44032
  s_and_b32 s58, s58, 0xffff
  buffer_load_dwordx4 v[108:111], v4, s[24:27], s58 offen nt
  v_add_f32_dpp v16, v16, v16 row_ror:8 row_mask:0xf bank_mask:0xf
  v_add_f32_dpp v17, v17, v17 row_ror:8 row_mask:0xf bank_mask:0xf
  v_add_f32_dpp v18, v18, v18 row_ror:8 row_mask:0xf bank_mask:0xf
  v_add_f32_dpp v19, v19, v19 row_ror:8 row_mask:0xf bank_mask:0xf
  v_add_f32_dpp v16, v16, v16 row_ror:4 row_mask:0xf bank_mask:0xf
  v_add_f32_dpp v17, v17, v17 row_ror:4 row_mask:0xf bank_mask:0xf
  v_add_f32_dpp v18, v18, v18 row_ror:4 row_mask:0xf bank_mask:0xf
  v_add_f32_dpp v19, v19, v19 row_ror:4 row_mask:0xf bank_mask:0xf
  v_add_f32_dpp v16, v16, v16 row_ror:2 row_mask:0xf bank_mask:0xf
  v_add_f32_dpp v17, v17, v17 row_ror:2 row_mask:0xf bank_mask:0xf
  v_add_f32_dpp v18, v18, v18 row_ror:2 row_mask:0xf bank_mask:0xf
  v_add_f32_dpp v19, v19, v19 row_ror:2 row_mask:0xf bank_mask:0xf
  v_add_f32_dpp v16, v16, v16 row_ror:1 row_mask:0xf bank_mask:0xf
  v_add_f32_dpp v17, v17, v17 row_ror:1 row_mask:0xf bank_mask:0xf
  v_add_f32_dpp v18, v18, v18 row_ror:1 row_mask:0xf bank_mask:0xf
  v_add_f32_dpp v19, v19, v19 row_ror:1 row_mask:0xf bank_mask:0xf
  v_cndmask_b32_e64 v13, v13, v16, s[80:81]
  v_cndmask_b32_e64 v13, v13, v17, s[82:83]
  v_cndmask_b32_e64 v13, v13, v18, s[84:85]
  v_cndmask_b32_e64 v13, v13, v19, s[86:87]
  s_waitcnt vmcnt(12)
  v_dot2_f32_bf16 v16, v112, v8, 0
  v_dot2_f32_bf16 v17, v116, v8, 0
  v_dot2_f32_bf16 v18, v120, v8, 0
  v_dot2_f32_bf16 v19, v124, v8, 0
  v_dot2_f32_bf16 v16, v113, v9, v16
  v_dot2_f32_bf16 v17, v117, v9, v17
  v_dot2_f32_bf16 v18, v121, v9, v18
  v_dot2_f32_bf16 v19, v125, v9, v19
  v_dot2_f32_bf16 v16, v114, v10, v16
  v_dot2_f32_bf16 v17, v118, v10, v17
  v_dot2_f32_bf16 v18, v122, v10, v18
  v_dot2_f32_bf16 v19, v126, v10, v19
  v_dot2_f32_bf16 v16, v115, v11, v16
  v_dot2_f32_bf16 v17, v119, v11, v17
  v_dot2_f32_bf16 v18, v123, v11, v18
  v_dot2_f32_bf16 v19, v127, v11, v19
  s_add_u32 s58, s23, 45056
  s_and_b32 s58, s58, 0xffff
  buffer_load_dwordx4 v[112:115], v4, s[24:27], s58 offen nt
  s_add_u32 s58, s23, 46080
  s_and_b32 s58, s58, 0xffff
  buffer_load_dwordx4 v[116:119], v4, s[24:27], s58 offen nt
  s_add_u32 s58, s23, 47104
  s_and_b32 s58, s58, 0xffff
  buffer_load_dwordx4 v[120:123], v4, s[24:27], s58 offen nt
  s_add_u32 s58, s23, 48128
  s_and_b32 s58, s58, 0xffff
  buffer_load_dwordx4 v[124:127], v4, s[24:27], s58 offen nt
  v_add_f32_dpp v16, v16, v16 row_ror:8 row_mask:0xf bank_mask:0xf
  v_add_f32_dpp v17, v17, v17 row_ror:8 row_mask:0xf bank_mask:0xf
  v_add_f32_dpp v18, v18, v18 row_ror:8 row_mask:0xf bank_mask:0xf
  v_add_f32_dpp v19, v19, v19 row_ror:8 row_mask:0xf bank_mask:0xf
  v_add_f32_dpp v16, v16, v16 row_ror:4 row_mask:0xf bank_mask:0xf
  v_add_f32_dpp v17, v17, v17 row_ror:4 row_mask:0xf bank_mask:0xf
  v_add_f32_dpp v18, v18, v18 row_ror:4 row_mask:0xf bank_mask:0xf
  v_add_f32_dpp v19, v19, v19 row_ror:4 row_mask:0xf bank_mask:0xf
  v_add_f32_dpp v16, v16, v16 row_ror:2 row_mask:0xf bank_mask:0xf
  v_add_f32_dpp v17, v17, v17 row_ror:2 row_mask:0xf bank_mask:0xf
  v_add_f32_dpp v18, v18, v18 row_ror:2 row_mask:0xf bank_mask:0xf
  v_add_f32_dpp v19, v19, v19 row_ror:2 row_mask:0xf bank_mask:0xf
  v_add_f32_dpp v16, v16, v16 row_ror:1 row_mask:0xf bank_mask:0xf
  v_add_f32_dpp v17, v17, v17 row_ror:1 row_mask:0xf bank_mask:0xf
  v_add_f32_dpp v18, v18, v18 row_ror:1 row_mask:0xf bank_mask:0xf
  v_add_f32_dpp v19, v19, v19 row_ror:1 row_mask:0xf bank_mask:0xf
  v_cndmask_b32_e64 v13, v13, v16, s[88:89]
  v_cndmask_b32_e64 v13, v13, v17, s[90:91]
  v_cndmask_b32_e64 v13, v13, v18, s[92:93]
  v_cndmask_b32_e64 v13, v13, v19, s[94:95]
  s_waitcnt vmcnt(12)
  v_dot2_f32_bf16 v16, v64, v8, 0
  v_dot2_f32_bf16 v17, v68, v8, 0
  v_dot2_f32_bf16 v18, v72, v8, 0
  v_dot2_f32_bf16 v19, v76, v8, 0
  v_dot2_f32_bf16 v16, v65, v9, v16
  v_dot2_f32_bf16 v17, v69, v9, v17
  v_dot2_f32_bf16 v18, v73, v9, v18
  v_dot2_f32_bf16 v19, v77, v9, v19
  v_dot2_f32_bf16 v16, v66, v10, v16
  v_dot2_f32_bf16 v17, v70, v10, v17
  v_dot2_f32_bf16 v18, v74, v10, v18
  v_dot2_f32_bf16 v19, v78, v10, v19
  v_dot2_f32_bf16 v16, v67, v11, v16
  v_dot2_f32_bf16 v17, v71, v11, v17
  v_dot2_f32_bf16 v18, v75, v11, v18
  v_dot2_f32_bf16 v19, v79, v11, v19
  s_add_u32 s58, s23, 49152
  s_and_b32 s58, s58, 0xffff
  buffer_load_dwordx4 v[64:67], v4, s[24:27], s58 offen nt
  s_add_u32 s58, s23, 50176
  s_and_b32 s58, s58, 0xffff
  buffer_load_dwordx4 v[68:71], v4, s[24:27], s58 offen nt
  s_add_u32 s58, s23, 51200
  s_and_b32 s58, s58, 0xffff
  buffer_load_dwordx4 v[72:75], v4, s[24:27], s58 offen nt
  s_add_u32 s58, s23, 52224
  s_and_b32 s58, s58, 0xffff
  buffer_load_dwordx4 v[76:79], v4, s[24:27], s58 offen nt
  v_add_f32_dpp v16, v16, v16 row_ror:8 row_mask:0xf bank_mask:0xf
  v_add_f32_dpp v17, v17, v17 row_ror:8 row_mask:0xf bank_mask:0xf
  v_add_f32_dpp v18, v18, v18 row_ror:8 row_mask:0xf bank_mask:0xf
  v_add_f32_dpp v19, v19, v19 row_ror:8 row_mask:0xf bank_mask:0xf
  v_add_f32_dpp v16, v16, v16 row_ror:4 row_mask:0xf bank_mask:0xf
  v_add_f32_dpp v17, v17, v17 row_ror:4 row_mask:0xf bank_mask:0xf
  v_add_f32_dpp v18, v18, v18 row_ror:4 row_mask:0xf bank_mask:0xf
  v_add_f32_dpp v19, v19, v19 row_ror:4 row_mask:0xf bank_mask:0xf
  v_add_f32_dpp v16, v16, v16 row_ror:2 row_mask:0xf bank_mask:0xf
  v_add_f32_dpp v17, v17, v17 row_ror:2 row_mask:0xf bank_mask:0xf
  v_add_f32_dpp v18, v18, v18 row_ror:2 row_mask:0xf bank_mask:0xf
  v_add_f32_dpp v19, v19, v19 row_ror:2 row_mask:0xf bank_mask:0xf
  v_add_f32_dpp v16, v16, v16 row_ror:1 row_mask:0xf bank_mask:0xf
  v_add_f32_dpp v17, v17, v17 row_ror:1 row_mask:0xf bank_mask:0xf
  v_add_f32_dpp v18, v18, v18 row_ror:1 row_mask:0xf bank_mask:0xf
  v_add_f32_dpp v19, v19, v19 row_ror:1 row_mask:0xf bank_mask:0xf
  v_cndmask_b32_e64 v14, v14, v16, s[64:65]
  v_cndmask_b32_e64 v14, v14, v17, s[66:67]
  v_cndmask_b32_e64 v14, v14, v18, s[68:69]
  v_cndmask_b32_e64 v14, v14, v19, s[70:71]
  s_waitcnt vmcnt(12)
  v_dot2_f32_bf16 v16, v80, v8, 0
  v_dot2_f32_bf16 v17, v84, v8, 0
  v_dot2_f32_bf16 v18, v88, v8, 0
  v_dot2_f32_bf16 v19, v92, v8, 0
  v_dot2_f32_bf16 v16, v81, v9, v16
  v_dot2_f32_bf16 v17, v85, v9, v17
  v_dot2_f32_bf16 v18, v89, v9, v18
  v_dot2_f32_bf16 v19, v93, v9, v19
  v_dot2_f32_bf16 v16, v82, v10, v16
  v_dot2_f32_bf16 v17, v86, v10, v17
  v_dot2_f32_bf16 v18, v90, v10, v18
  v_dot2_f32_bf16 v19, v94, v10, v19
  v_dot2_f32_bf16 v16, v83, v11, v16
  v_dot2_f32_bf16 v17, v87, v11, v17
  v_dot2_f32_bf16 v18, v91, v11, v18
  v_dot2_f32_bf16 v19, v95, v11, v19
  s_add_u32 s58, s23, 53248
  s_and_b32 s58, s58, 0xffff
  buffer_load_dwordx4 v[80:83], v4, s[24:27], s58 offen nt
  s_add_u32 s58, s23, 54272
  s_and_b32 s58, s58, 0xffff
  buffer_load_dwordx4 v[84:87], v4, s[24:27], s58 offen nt
  s_add_u32 s58, s23, 55296
  s_and_b32 s58, s58, 0xffff
  buffer_load_dwordx4 v[88:91], v4, s[24:27], s58 offen nt
  s_add_u32 s58, s23, 56320
  s_and_b32 s58, s58, 0xffff
  buffer_load_dwordx4 v[92:95], v4, s[24:27], s58 offen nt
  v_add_f32_dpp v16, v16, v16 row_ror:8 row_mask:0xf bank_mask:0xf
  v_add_f32_dpp v17, v17, v17 row_ror:8 row_mask:0xf bank_mask:0xf
  v_add_f32_dpp v18, v18, v18 row_ror:8 row_mask:0xf bank_mask:0xf
  v_add_f32_dpp v19, v19, v19 row_ror:8 row_mask:0xf bank_mask:0xf
  v_add_f32_dpp v16, v16, v16 row_ror:4 row_mask:0xf bank_mask:0xf
  v_add_f32_dpp v17, v17, v17 row_ror:4 row_mask:0xf bank_mask:0xf
  v_add_f32_dpp v18, v18, v18 row_ror:4 row_mask:0xf bank_mask:0xf
  v_add_f32_dpp v19, v19, v19 row_ror:4 row_mask:0xf bank_mask:0xf
  v_add_f32_dpp v16, v16, v16 row_ror:2 row_mask:0xf bank_mask:0xf
  v_add_f32_dpp v17, v17, v17 row_ror:2 row_mask:0xf bank_mask:0xf
  v_add_f32_dpp v18, v18, v18 row_ror:2 row_mask:0xf bank_mask:0xf
  v_add_f32_dpp v19, v19, v19 row_ror:2 row_mask:0xf bank_mask:0xf
  v_add_f32_dpp v16, v16, v16 row_ror:1 row_mask:0xf bank_mask:0xf
  v_add_f32_dpp v17, v17, v17 row_ror:1 row_mask:0xf bank_mask:0xf
  v_add_f32_dpp v18, v18, v18 row_ror:1 row_mask:0xf bank_mask:0xf
  v_add_f32_dpp v19, v19, v19 row_ror:1 row_mask:0xf bank_mask:0xf
  v_cndmask_b32_e64 v14, v14, v16, s[72:73]
  v_cndmask_b32_e64 v14, v14, v17, s[74:75]
  v_cndmask_b32_e64 v14, v14, v18, s[76:77]
  v_cndmask_b32_e64 v14, v14, v19, s[78:79]
  s_waitcnt vmcnt(12)
  v_dot2_f32_bf16 v16, v96, v8, 0
  v_dot2_f32_bf16 v17, v100, v8, 0
  v_dot2_f32_bf16 v18, v104, v8, 0
  v_dot2_f32_bf16 v19, v108, v8, 0
  v_dot2_f32_bf16 v16, v97, v9, v16
  v_dot2_f32_bf16 v17, v101, v9, v17
  v_dot2_f32_bf16 v18, v105, v9, v18
  v_dot2_f32_bf16 v19, v109, v9, v19
  v_dot2_f32_bf16 v16, v98, v10, v16
  v_dot2_f32_bf16 v17, v102, v10, v17
  v_dot2_f32_bf16 v18, v106, v10, v18
  v_dot2_f32_bf16 v19, v110, v10, v19
  v_dot2_f32_bf16 v16, v99, v11, v16
  v_dot2_f32_bf16 v17, v103, v11, v17
  v_dot2_f32_bf16 v18, v107, v11, v18
  v_dot2_f32_bf16 v19, v111, v11, v19
  s_add_u32 s58, s23, 57344
  s_and_b32 s58, s58, 0xffff
  buffer_load_dwordx4 v[96:99], v4, s[24:27], s58 offen nt
  s_add_u32 s58, s23, 58368
  s_and_b32 s58, s58, 0xffff
  buffer_load_dwordx4 v[100:103], v4, s[24:27], s58 offen nt
  s_add_u32 s58, s23, 59392
  s_and_b32 s58, s58, 0xffff
  buffer_load_dwordx4 v[104:107], v4, s[24:27], s58 offen nt
  s_add_u32 s58, s23, 60416
  s_and_b32 s58, s58, 0xffff
  buffer_load_dwordx4 v[108:111], v4, s[24:27], s58 offen nt
  v_add_f32_dpp v16, v16, v16 row_ror:8 row_mask:0xf bank_mask:0xf
  v_add_f32_dpp v17, v17, v17 row_ror:8 row_mask:0xf bank_mask:0xf
  v_add_f32_dpp v18, v18, v18 row_ror:8 row_mask:0xf bank_mask:0xf
  v_add_f32_dpp v19, v19, v19 row_ror:8 row_mask:0xf bank_mask:0xf
  v_add_f32_dpp v16, v16, v16 row_ror:4 row_mask:0xf bank_mask:0xf
  v_add_f32_dpp v17, v17, v17 row_ror:4 row_mask:0xf bank_mask:0xf
  v_add_f32_dpp v18, v18, v18 row_ror:4 row_mask:0xf bank_mask:0xf
  v_add_f32_dpp v19, v19, v19 row_ror:4 row_mask:0xf bank_mask:0xf
  v_add_f32_dpp v16, v16, v16 row_ror:2 row_mask:0xf bank_mask:0xf
  v_add_f32_dpp v17, v17, v17 row_ror:2 row_mask:0xf bank_mask:0xf
  v_add_f32_dpp v18, v18, v18 row_ror:2 row_mask:0xf bank_mask:0xf
  v_add_f32_dpp v19, v19, v19 row_ror:2 row_mask:0xf bank_mask:0xf
  v_add_f32_dpp v16, v16, v16 row_ror:1 row_mask:0xf bank_mask:0xf
  v_add_f32_dpp v17, v17, v17 row_ror:1 row_mask:0xf bank_mask:0xf
  v_add_f32_dpp v18, v18, v18 row_ror:1 row_mask:0xf bank_mask:0xf
  v_add_f32_dpp v19, v19, v19 row_ror:1 row_mask:0xf bank_mask:0xf
  v_cndmask_b32_e64 v14, v14, v16, s[80:81]
  v_cndmask_b32_e64 v14, v14, v17, s[82:83]
  v_cndmask_b32_e64 v14, v14, v18, s[84:85]
  v_cndmask_b32_e64 v14, v14, v19, s[86:87]
  s_waitcnt vmcnt(12)
  v_dot2_f32_bf16 v16, v112, v8, 0
  v_dot2_f32_bf16 v17, v116, v8, 0
  v_dot2_f32_bf16 v18, v120, v8, 0
  v_dot2_f32_bf16 v19, v124, v8, 0
  v_dot2_f32_bf16 v16, v113, v9, v16
  v_dot2_f32_bf16 v17, v117, v9, v17
  v_dot2_f32_bf16 v18, v121, v9, v18
  v_dot2_f32_bf16 v19, v125, v9, v19
  v_dot2_f32_bf16 v16, v114, v10, v16
  v_dot2_f32_bf16 v17, v118, v10, v17
  v_dot2_f32_bf16 v18, v122, v10, v18
  v_dot2_f32_bf16 v19, v126, v10, v19
  v_dot2_f32_bf16 v16, v115, v11, v16
  v_dot2_f32_bf16 v17, v119, v11, v17
  v_dot2_f32_bf16 v18, v123, v11, v18
  v_dot2_f32_bf16 v19, v127, v11, v19
  s_add_u32 s58, s23, 61440
  s_and_b32 s58, s58, 0xffff
  buffer_load_dwordx4 v[112:115], v4, s[24:27], s58 offen nt
  s_add_u32 s58, s23, 62464
  s_and_b32 s58, s58, 0xffff
  buffer_load_dwordx4 v[116:119], v4, s[24:27], s58 offen nt
  s_add_u32 s58, s23, 63488
  s_and_b32 s58, s58, 0xffff
  buffer_load_dwordx4 v[120:123], v4, s[24:27], s58 offen nt
  s_add_u32 s58, s23, 64512
  s_and_b32 s58, s58, 0xffff
  buffer_load_dwordx4 v[124:127], v4, s[24:27], s58 offen nt
  v_add_f32_dpp v16, v16, v16 row_ror:8 row_mask:0xf bank_mask:0xf
  v_add_f32_dpp v17, v17, v17 row_ror:8 row_mask:0xf bank_mask:0xf
  v_add_f32_dpp v18, v18, v18 row_ror:8 row_mask:0xf bank_mask:0xf
  v_add_f32_dpp v19, v19, v19 row_ror:8 row_mask:0xf bank_mask:0xf
  v_add_f32_dpp v16, v16, v16 row_ror:4 row_mask:0xf bank_mask:0xf
  v_add_f32_dpp v17, v17, v17 row_ror:4 row_mask:0xf bank_mask:0xf
  v_add_f32_dpp v18, v18, v18 row_ror:4 row_mask:0xf bank_mask:0xf
  v_add_f32_dpp v19, v19, v19 row_ror:4 row_mask:0xf bank_mask:0xf
  v_add_f32_dpp v16, v16, v16 row_ror:2 row_mask:0xf bank_mask:0xf
  v_add_f32_dpp v17, v17, v17 row_ror:2 row_mask:0xf bank_mask:0xf
  v_add_f32_dpp v18, v18, v18 row_ror:2 row_mask:0xf bank_mask:0xf
  v_add_f32_dpp v19, v19, v19 row_ror:2 row_mask:0xf bank_mask:0xf
  v_add_f32_dpp v16, v16, v16 row_ror:1 row_mask:0xf bank_mask:0xf
  v_add_f32_dpp v17, v17, v17 row_ror:1 row_mask:0xf bank_mask:0xf
  v_add_f32_dpp v18, v18, v18 row_ror:1 row_mask:0xf bank_mask:0xf
  v_add_f32_dpp v19, v19, v19 row_ror:1 row_mask:0xf bank_mask:0xf
  v_cndmask_b32_e64 v14, v14, v16, s[88:89]
  v_cndmask_b32_e64 v14, v14, v17, s[90:91]
  v_cndmask_b32_e64 v14, v14, v18, s[92:93]
  v_cndmask_b32_e64 v14, v14, v19, s[94:95]
  s_waitcnt vmcnt(12)
  v_dot2_f32_bf16 v16, v64, v8, 0
  v_dot2_f32_bf16 v17, v68, v8, 0
  v_dot2_f32_bf16 v18, v72, v8, 0
  v_dot2_f32_bf16 v19, v76, v8, 0
  v_dot2_f32_bf16 v16, v65, v9, v16
  v_dot2_f32_bf16 v17, v69, v9, v17
  v_dot2_f32_bf16 v18, v73, v9, v18
  v_dot2_f32_bf16 v19, v77, v9, v19
  v_dot2_f32_bf16 v16, v66, v10, v16
  v_dot2_f32_bf16 v17, v70, v10, v17
  v_dot2_f32_bf16 v18, v74, v10, v18
  v_dot2_f32_bf16 v19, v78, v10, v19
  v_dot2_f32_bf16 v16, v67, v11, v16
  v_dot2_f32_bf16 v17, v71, v11, v17
  v_dot2_f32_bf16 v18, v75, v11, v18
  v_dot2_f32_bf16 v19, v79, v11, v19
  s_add_u32 s58, s23, 0
  s_and_b32 s58, s58, 0xffff
  buffer_load_dwordx4 v[64:67], v4, s[28:31], s58 offen nt
  s_add_u32 s58, s23, 1024
  s_and_b32 s58, s58, 0xffff
  buffer_load_dwordx4 v[68:71], v4, s[28:31], s58 offen nt
  s_add_u32 s58, s23, 2048
  s_and_b32 s58, s58, 0xffff
  buffer_load_dwordx4 v[72:75], v4, s[28:31], s58 offen nt
  s_add_u32 s58, s23, 3072
  s_and_b32 s58, s58, 0xffff
  buffer_load_dwordx4 v[76:79], v4, s[28:31], s58 offen nt
  v_add_f32_dpp v16, v16, v16 row_ror:8 row_mask:0xf bank_mask:0xf
  v_add_f32_dpp v17, v17, v17 row_ror:8 row_mask:0xf bank_mask:0xf
  v_add_f32_dpp v18, v18, v18 row_ror:8 row_mask:0xf bank_mask:0xf
  v_add_f32_dpp v19, v19, v19 row_ror:8 row_mask:0xf bank_mask:0xf
  v_add_f32_dpp v16, v16, v16 row_ror:4 row_mask:0xf bank_mask:0xf
  v_add_f32_dpp v17, v17, v17 row_ror:4 row_mask:0xf bank_mask:0xf
  v_add_f32_dpp v18, v18, v18 row_ror:4 row_mask:0xf bank_mask:0xf
  v_add_f32_dpp v19, v19, v19 row_ror:4 row_mask:0xf bank_mask:0xf
  v_add_f32_dpp v16, v16, v16 row_ror:2 row_mask:0xf bank_mask:0xf
  v_add_f32_dpp v17, v17, v17 row_ror:2 row_mask:0xf bank_mask:0xf
  v_add_f32_dpp v18, v18, v18 row_ror:2 row_mask:0xf bank_mask:0xf
  v_add_f32_dpp v19, v19, v19 row_ror:2 row_mask:0xf bank_mask:0xf
  v_add_f32_dpp v16, v16, v16 row_ror:1 row_mask:0xf bank_mask:0xf
  v_add_f32_dpp v17, v17, v17 row_ror:1 row_mask:0xf bank_mask:0xf
  v_add_f32_dpp v18, v18, v18 row_ror:1 row_mask:0xf bank_mask:0xf
  v_add_f32_dpp v19, v19, v19 row_ror:1 row_mask:0xf bank_mask:0xf
  v_cndmask_b32_e64 v15, v15, v16, s[64:65]
  v_cndmask_b32_e64 v15, v15, v17, s[66:67]
  v_cndmask_b32_e64 v15, v15, v18, s[68:69]
  v_cndmask_b32_e64 v15, v15, v19, s[70:71]
  s_waitcnt vmcnt(12)
  v_dot2_f32_bf16 v16, v80, v8, 0
  v_dot2_f32_bf16 v17, v84, v8, 0
  v_dot2_f32_bf16 v18, v88, v8, 0
  v_dot2_f32_bf16 v19, v92, v8, 0
  v_dot2_f32_bf16 v16, v81, v9, v16
  v_dot2_f32_bf16 v17, v85, v9, v17
  v_dot2_f32_bf16 v18, v89, v9, v18
  v_dot2_f32_bf16 v19, v93, v9, v19
  v_dot2_f32_bf16 v16, v82, v10, v16
  v_dot2_f32_bf16 v17, v86, v10, v17
  v_dot2_f32_bf16 v18, v90, v10, v18
  v_dot2_f32_bf16 v19, v94, v10, v19
  v_dot2_f32_bf16 v16, v83, v11, v16
  v_dot2_f32_bf16 v17, v87, v11, v17
  v_dot2_f32_bf16 v18, v91, v11, v18
  v_dot2_f32_bf16 v19, v95, v11, v19
  s_add_u32 s58, s23, 4096
  s_and_b32 s58, s58, 0xffff
  buffer_load_dwordx4 v[80:83], v4, s[28:31], s58 offen nt
  s_add_u32 s58, s23, 5120
  s_and_b32 s58, s58, 0xffff
  buffer_load_dwordx4 v[84:87], v4, s[28:31], s58 offen nt
  s_add_u32 s58, s23, 6144
  s_and_b32 s58, s58, 0xffff
  buffer_load_dwordx4 v[88:91], v4, s[28:31], s58 offen nt
  s_add_u32 s58, s23, 7168
  s_and_b32 s58, s58, 0xffff
  buffer_load_dwordx4 v[92:95], v4, s[28:31], s58 offen nt
  v_add_f32_dpp v16, v16, v16 row_ror:8 row_mask:0xf bank_mask:0xf
  v_add_f32_dpp v17, v17, v17 row_ror:8 row_mask:0xf bank_mask:0xf
  v_add_f32_dpp v18, v18, v18 row_ror:8 row_mask:0xf bank_mask:0xf
  v_add_f32_dpp v19, v19, v19 row_ror:8 row_mask:0xf bank_mask:0xf
  v_add_f32_dpp v16, v16, v16 row_ror:4 row_mask:0xf bank_mask:0xf
  v_add_f32_dpp v17, v17, v17 row_ror:4 row_mask:0xf bank_mask:0xf
  v_add_f32_dpp v18, v18, v18 row_ror:4 row_mask:0xf bank_mask:0xf
  v_add_f32_dpp v19, v19, v19 row_ror:4 row_mask:0xf bank_mask:0xf
  v_add_f32_dpp v16, v16, v16 row_ror:2 row_mask:0xf bank_mask:0xf
  v_add_f32_dpp v17, v17, v17 row_ror:2 row_mask:0xf bank_mask:0xf
  v_add_f32_dpp v18, v18, v18 row_ror:2 row_mask:0xf bank_mask:0xf
  v_add_f32_dpp v19, v19, v19 row_ror:2 row_mask:0xf bank_mask:0xf
  v_add_f32_dpp v16, v16, v16 row_ror:1 row_mask:0xf bank_mask:0xf
  v_add_f32_dpp v17, v17, v17 row_ror:1 row_mask:0xf bank_mask:0xf
  v_add_f32_dpp v18, v18, v18 row_ror:1 row_mask:0xf bank_mask:0xf
  v_add_f32_dpp v19, v19, v19 row_ror:1 row_mask:0xf bank_mask:0xf
  v_cndmask_b32_e64 v15, v15, v16, s[72:73]
  v_cndmask_b32_e64 v15, v15, v17, s[74:75]
  v_cndmask_b32_e64 v15, v15, v18, s[76:77]
  v_cndmask_b32_e64 v15, v15, v19, s[78:79]
  s_waitcnt vmcnt(12)
  v_dot2_f32_bf16 v16, v96, v8, 0
  v_dot2_f32_bf16 v17, v100, v8, 0
  v_dot2_f32_bf16 v18, v104, v8, 0
  v_dot2_f32_bf16 v19, v108, v8, 0
  v_dot2_f32_bf16 v16, v97, v9, v16
  v_dot2_f32_bf16 v17, v101, v9, v17
  v_dot2_f32_bf16 v18, v105, v9, v18
  v_dot2_f32_bf16 v19, v109, v9, v19
  v_dot2_f32_bf16 v16, v98, v10, v16
  v_dot2_f32_bf16 v17, v102, v10, v17
  v_dot2_f32_bf16 v18, v106, v10, v18
  v_dot2_f32_bf16 v19, v110, v10, v19
  v_dot2_f32_bf16 v16, v99, v11, v16
  v_dot2_f32_bf16 v17, v103, v11, v17
  v_dot2_f32_bf16 v18, v107, v11, v18
  v_dot2_f32_bf16 v19, v111, v11, v19
  s_add_u32 s58, s23, 8192
  s_and_b32 s58, s58, 0xffff
  buffer_load_dwordx4 v[96:99], v4, s[28:31], s58 offen nt
  s_add_u32 s58, s23, 9216
  s_and_b32 s58, s58, 0xffff
  buffer_load_dwordx4 v[100:103], v4, s[28:31], s58 offen nt
  s_add_u32 s58, s23, 10240
  s_and_b32 s58, s58, 0xffff
  buffer_load_dwordx4 v[104:107], v4, s[28:31], s58 offen nt
  s_add_u32 s58, s23, 11264
  s_and_b32 s58, s58, 0xffff
  buffer_load_dwordx4 v[108:111], v4, s[28:31], s58 offen nt
  v_add_f32_dpp v16, v16, v16 row_ror:8 row_mask:0xf bank_mask:0xf
  v_add_f32_dpp v17, v17, v17 row_ror:8 row_mask:0xf bank_mask:0xf
  v_add_f32_dpp v18, v18, v18 row_ror:8 row_mask:0xf bank_mask:0xf
  v_add_f32_dpp v19, v19, v19 row_ror:8 row_mask:0xf bank_mask:0xf
  v_add_f32_dpp v16, v16, v16 row_ror:4 row_mask:0xf bank_mask:0xf
  v_add_f32_dpp v17, v17, v17 row_ror:4 row_mask:0xf bank_mask:0xf
  v_add_f32_dpp v18, v18, v18 row_ror:4 row_mask:0xf bank_mask:0xf
  v_add_f32_dpp v19, v19, v19 row_ror:4 row_mask:0xf bank_mask:0xf
  v_add_f32_dpp v16, v16, v16 row_ror:2 row_mask:0xf bank_mask:0xf
  v_add_f32_dpp v17, v17, v17 row_ror:2 row_mask:0xf bank_mask:0xf
  v_add_f32_dpp v18, v18, v18 row_ror:2 row_mask:0xf bank_mask:0xf
  v_add_f32_dpp v19, v19, v19 row_ror:2 row_mask:0xf bank_mask:0xf
  v_add_f32_dpp v16, v16, v16 row_ror:1 row_mask:0xf bank_mask:0xf
  v_add_f32_dpp v17, v17, v17 row_ror:1 row_mask:0xf bank_mask:0xf
  v_add_f32_dpp v18, v18, v18 row_ror:1 row_mask:0xf bank_mask:0xf
  v_add_f32_dpp v19, v19, v19 row_ror:1 row_mask:0xf bank_mask:0xf
  v_cndmask_b32_e64 v15, v15, v16, s[80:81]
  v_cndmask_b32_e64 v15, v15, v17, s[82:83]
  v_cndmask_b32_e64 v15, v15, v18, s[84:85]
  v_cndmask_b32_e64 v15, v15, v19, s[86:87]
  s_waitcnt vmcnt(12)
  v_dot2_f32_bf16 v16, v112, v8, 0
  v_dot2_f32_bf16 v17, v116, v8, 0
  v_dot2_f32_bf16 v18, v120, v8, 0
  v_dot2_f32_bf16 v19, v124, v8, 0
  v_dot2_f32_bf16 v16, v113, v9, v16
  v_dot2_f32_bf16 v17, v117, v9, v17
  v_dot2_f32_bf16 v18, v121, v9, v18
  v_dot2_f32_bf16 v19, v125, v9, v19
  v_dot2_f32_bf16 v16, v114, v10, v16
  v_dot2_f32_bf16 v17, v118, v10, v17
  v_dot2_f32_bf16 v18, v122, v10, v18
  v_dot2_f32_bf16 v19, v126, v10, v19
  v_dot2_f32_bf16 v16, v115, v11, v16
  v_dot2_f32_bf16 v17, v119, v11, v17
  v_dot2_f32_bf16 v18, v123, v11, v18
  v_dot2_f32_bf16 v19, v127, v11, v19
  s_add_u32 s58, s23, 12288
  s_and_b32 s58, s58, 0xffff
  buffer_load_dwordx4 v[112:115], v4, s[28:31], s58 offen nt
  s_add_u32 s58, s23, 13312
  s_and_b32 s58, s58, 0xffff
  buffer_load_dwordx4 v[116:119], v4, s[28:31], s58 offen nt
  s_add_u32 s58, s23, 14336
  s_and_b32 s58, s58, 0xffff
  buffer_load_dwordx4 v[120:123], v4, s[28:31], s58 offen nt
  s_add_u32 s58, s23, 15360
  s_and_b32 s58, s58, 0xffff
  buffer_load_dwordx4 v[124:127], v4, s[28:31], s58 offen nt
  v_add_f32_dpp v16, v16, v16 row_ror:8 row_mask:0xf bank_mask:0xf
  v_add_f32_dpp v17, v17, v17 row_ror:8 row_mask:0xf bank_mask:0xf
  v_add_f32_dpp v18, v18, v18 row_ror:8 row_mask:0xf bank_mask:0xf
  v_add_f32_dpp v19, v19, v19 row_ror:8 row_mask:0xf bank_mask:0xf
  v_add_f32_dpp v16, v16, v16 row_ror:4 row_mask:0xf bank_mask:0xf
  v_add_f32_dpp v17, v17, v17 row_ror:4 row_mask:0xf bank_mask:0xf
  v_add_f32_dpp v18, v18, v18 row_ror:4 row_mask:0xf bank_mask:0xf
  v_add_f32_dpp v19, v19, v19 row_ror:4 row_mask:0xf bank_mask:0xf
  v_add_f32_dpp v16, v16, v16 row_ror:2 row_mask:0xf bank_mask:0xf
  v_add_f32_dpp v17, v17, v17 row_ror:2 row_mask:0xf bank_mask:0xf
  v_add_f32_dpp v18, v18, v18 row_ror:2 row_mask:0xf bank_mask:0xf
  v_add_f32_dpp v19, v19, v19 row_ror:2 row_mask:0xf bank_mask:0xf
  v_add_f32_dpp v16, v16, v16 row_ror:1 row_mask:0xf bank_mask:0xf
  v_add_f32_dpp v17, v17, v17 row_ror:1 row_mask:0xf bank_mask:0xf
  v_add_f32_dpp v18, v18, v18 row_ror:1 row_mask:0xf bank_mask:0xf
  v_add_f32_dpp v19, v19, v19 row_ror:1 row_mask:0xf bank_mask:0xf
  v_cndmask_b32_e64 v15, v15, v16, s[88:89]
  v_cndmask_b32_e64 v15, v15, v17, s[90:91]
  v_cndmask_b32_e64 v15, v15, v18, s[92:93]
  v_cndmask_b32_e64 v15, v15, v19, s[94:95]
  v_cvt_pk_bf16_f32 v12, v12, v12
  v_and_b32 v12, 0xffff0000, v12
  v_mul_f32 v12, 0x3db504f3, v12
  v_cvt_pk_bf16_f32 v12, v12, v12
  v_and_b32 v12, 0xffff0000, v12
  v_cvt_pk_bf16_f32 v13, v13, v13
  v_and_b32 v13, 0xffff0000, v13
  v_mul_f32 v13, 0x3db504f3, v13
  v_cvt_pk_bf16_f32 v13, v13, v13
  v_and_b32 v13, 0xffff0000, v13
  v_cvt_pk_bf16_f32 v14, v14, v14
  v_and_b32 v14, 0xffff0000, v14
  v_mul_f32 v14, 0x3db504f3, v14
  v_cvt_pk_bf16_f32 v14, v14, v14
  v_and_b32 v14, 0xffff0000, v14
  v_cvt_pk_bf16_f32 v15, v15, v15
  v_and_b32 v15, 0xffff0000, v15
  v_mul_f32 v15, 0x3db504f3, v15
  v_cvt_pk_bf16_f32 v15, v15, v15
  v_and_b32 v15, 0xffff0000, v15
  v_max3_f32 v16, v12, v13, v14
  v_max_f32 v16, v16, v15
  s_nop 1
  v_max_f32_dpp v16, v16, v16 row_ror:8 row_mask:0xf bank_mask:0xf
  s_nop 1
  v_max_f32_dpp v16, v16, v16 row_ror:4 row_mask:0xf bank_mask:0xf
  s_nop 1
  v_max_f32_dpp v16, v16, v16 row_ror:2 row_mask:0xf bank_mask:0xf
  s_nop 1
  v_max_f32_dpp v16, v16, v16 row_ror:1 row_mask:0xf bank_mask:0xf
  s_nop 1
  v_max_f32_dpp v16, v16, v16 row_bcast:15 row_mask:0xa bank_mask:0xf
  s_nop 1
  v_max_f32_dpp v16, v16, v16 row_bcast:31 row_mask:0xc bank_mask:0xf
  s_nop 0
  v_readlane_b32 s60, v16, 63
  s_nop 1
  v_mov_b32 v16, s60
  s_lshl_b32 s56, s20, 2
  v_mov_b32 v17, s56
  ds_write_b32 v17, v16 offset:9216
  v_lshlrev_b32 v7, 2, v2
  s_waitcnt lgkmcnt(0)
  s_barrier
  ds_read_b32 v16, v7 offset:9216
  s_waitcnt lgkmcnt(0)
  s_nop 1
  v_max_f32_dpp v16, v16, v16 row_ror:8 row_mask:0xf bank_mask:0xf
  s_nop 1
  v_max_f32_dpp v16, v16, v16 row_ror:4 row_mask:0xf bank_mask:0xf
  s_nop 1
  v_max_f32_dpp v16, v16, v16 row_ror:2 row_mask:0xf bank_mask:0xf
  s_nop 1
  v_max_f32_dpp v16, v16, v16 row_ror:1 row_mask:0xf bank_mask:0xf
  v_sub_f32 v12, v12, v16
  v_mul_f32 v12, 0x3fb8aa3b, v12
  v_exp_f32 v12, v12
  v_sub_f32 v13, v13, v16
  v_mul_f32 v13, 0x3fb8aa3b, v13
  v_exp_f32 v13, v13
  v_sub_f32 v14, v14, v16
  v_mul_f32 v14, 0x3fb8aa3b, v14
  v_exp_f32 v14, v14
  v_sub_f32 v15, v15, v16
  v_mul_f32 v15, 0x3fb8aa3b, v15
  v_exp_f32 v15, v15
  s_nop 0
  v_add_f32 v18, v12, v13
  v_add_f32 v19, v14, v15
  v_add_f32 v18, v18, v19
  s_nop 1
  v_add_f32_dpp v18, v18, v18 row_ror:8 row_mask:0xf bank_mask:0xf
  s_nop 1
  v_add_f32_dpp v18, v18, v18 row_ror:4 row_mask:0xf bank_mask:0xf
  s_nop 1
  v_add_f32_dpp v18, v18, v18 row_ror:2 row_mask:0xf bank_mask:0xf
  s_nop 1
  v_add_f32_dpp v18, v18, v18 row_ror:1 row_mask:0xf bank_mask:0xf
  s_nop 1
  v_add_f32_dpp v18, v18, v18 row_bcast:15 row_mask:0xa bank_mask:0xf
  s_nop 1
  v_add_f32_dpp v18, v18, v18 row_bcast:31 row_mask:0xc bank_mask:0xf
  s_nop 0
  v_readlane_b32 s60, v18, 63
  s_nop 1
  v_mov_b32 v18, s60
  ds_write_b32 v17, v18 offset:9280
  s_waitcnt lgkmcnt(0)
  s_barrier
  ds_read_b32 v18, v7 offset:9280
  s_waitcnt lgkmcnt(0)
  s_nop 1
  v_add_f32_dpp v18, v18, v18 row_ror:8 row_mask:0xf bank_mask:0xf
  s_nop 1
  v_add_f32_dpp v18, v18, v18 row_ror:4 row_mask:0xf bank_mask:0xf
  s_nop 1
  v_add_f32_dpp v18, v18, v18 row_ror:2 row_mask:0xf bank_mask:0xf
  s_nop 1
  v_add_f32_dpp v18, v18, v18 row_ror:1 row_mask:0xf bank_mask:0xf
  s_nop 0
  v_readlane_b32 s60, v18, 0
  s_nop 1
  v_mov_b32 v18, s60
  v_rcp_f32 v19, v18
  s_nop 0
  v_mul_f32 v24, v12, v19
  v_fma_f32 v25, -v24, v18, v12
  v_fma_f32 v24, v25, v19, v24
  v_cvt_pk_bf16_f32 v20, 0, v24
  v_cvt_pk_bf16_f32 v12, v24, 0
  v_mul_f32 v24, v13, v19
  v_fma_f32 v25, -v24, v18, v13
  v_fma_f32 v24, v25, v19, v24
  v_cvt_pk_bf16_f32 v21, 0, v24
  v_cvt_pk_bf16_f32 v13, v24, 0
  v_mul_f32 v24, v14, v19
  v_fma_f32 v25, -v24, v18, v14
  v_fma_f32 v24, v25, v19, v24
  v_cvt_pk_bf16_f32 v22, 0, v24
  v_cvt_pk_bf16_f32 v14, v24, 0
  v_mul_f32 v24, v15, v19
  v_fma_f32 v25, -v24, v18, v15
  v_fma_f32 v24, v25, v19, v24
  v_cvt_pk_bf16_f32 v23, 0, v24
  v_cvt_pk_bf16_f32 v15, v24, 0
  v_mov_b32 v24, 0
  v_mov_b32 v25, 0
  v_mov_b32 v26, 0
  v_mov_b32 v27, 0
  v_mov_b32 v28, 0
  v_mov_b32 v29, 0
  v_mov_b32 v30, 0
  v_mov_b32 v31, 0
  s_nop 1
  s_waitcnt vmcnt(12)
  v_dot2c_f32_bf16_dpp v24, v12, v64 row_newbcast:0 row_mask:0xf bank_mask:0xf
  v_dot2c_f32_bf16_dpp v25, v20, v64 row_newbcast:0 row_mask:0xf bank_mask:0xf
  v_dot2c_f32_bf16_dpp v26, v12, v65 row_newbcast:0 row_mask:0xf bank_mask:0xf
  v_dot2c_f32_bf16_dpp v27, v20, v65 row_newbcast:0 row_mask:0xf bank_mask:0xf
  v_dot2c_f32_bf16_dpp v28, v12, v66 row_newbcast:0 row_mask:0xf bank_mask:0xf
  v_dot2c_f32_bf16_dpp v29, v20, v66 row_newbcast:0 row_mask:0xf bank_mask:0xf
  v_dot2c_f32_bf16_dpp v30, v12, v67 row_newbcast:0 row_mask:0xf bank_mask:0xf
  v_dot2c_f32_bf16_dpp v31, v20, v67 row_newbcast:0 row_mask:0xf bank_mask:0xf
  s_add_u32 s58, s23, 16384
  s_and_b32 s58, s58, 0xffff
  buffer_load_dwordx4 v[64:67], v4, s[28:31], s58 offen nt
  v_dot2c_f32_bf16_dpp v24, v12, v68 row_newbcast:1 row_mask:0xf bank_mask:0xf
  v_dot2c_f32_bf16_dpp v25, v20, v68 row_newbcast:1 row_mask:0xf bank_mask:0xf
  v_dot2c_f32_bf16_dpp v26, v12, v69 row_newbcast:1 row_mask:0xf bank_mask:0xf
  v_dot2c_f32_bf16_dpp v27, v20, v69 row_newbcast:1 row_mask:0xf bank_mask:0xf
  v_dot2c_f32_bf16_dpp v28, v12, v70 row_newbcast:1 row_mask:0xf bank_mask:0xf
  v_dot2c_f32_bf16_dpp v29, v20, v70 row_newbcast:1 row_mask:0xf bank_mask:0xf
  v_dot2c_f32_bf16_dpp v30, v12, v71 row_newbcast:1 row_mask:0xf bank_mask:0xf
  v_dot2c_f32_bf16_dpp v31, v20, v71 row_newbcast:1 row_mask:0xf bank_mask:0xf
  s_add_u32 s58, s23, 17408
  s_and_b32 s58, s58, 0xffff
  buffer_load_dwordx4 v[68:71], v4, s[28:31], s58 offen nt
  v_dot2c_f32_bf16_dpp v24, v12, v72 row_newbcast:2 row_mask:0xf bank_mask:0xf
  v_dot2c_f32_bf16_dpp v25, v20, v72 row_newbcast:2 row_mask:0xf bank_mask:0xf
  v_dot2c_f32_bf16_dpp v26, v12, v73 row_newbcast:2 row_mask:0xf bank_mask:0xf
  v_dot2c_f32_bf16_dpp v27, v20, v73 row_newbcast:2 row_mask:0xf bank_mask:0xf
  v_dot2c_f32_bf16_dpp v28, v12, v74 row_newbcast:2 row_mask:0xf bank_mask:0xf
  v_dot2c_f32_bf16_dpp v29, v20, v74 row_newbcast:2 row_mask:0xf bank_mask:0xf
  v_dot2c_f32_bf16_dpp v30, v12, v75 row_newbcast:2 row_mask:0xf bank_mask:0xf
  v_dot2c_f32_bf16_dpp v31, v20, v75 row_newbcast:2 row_mask:0xf bank_mask:0xf
  s_add_u32 s58, s23, 18432
  s_and_b32 s58, s58, 0xffff
  buffer_load_dwordx4 v[72:75], v4, s[28:31], s58 offen nt
  v_dot2c_f32_bf16_dpp v24, v12, v76 row_newbcast:3 row_mask:0xf bank_mask:0xf
  v_dot2c_f32_bf16_dpp v25, v20, v76 row_newbcast:3 row_mask:0xf bank_mask:0xf
  v_dot2c_f32_bf16_dpp v26, v12, v77 row_newbcast:3 row_mask:0xf bank_mask:0xf
  v_dot2c_f32_bf16_dpp v27, v20, v77 row_newbcast:3 row_mask:0xf bank_mask:0xf
  v_dot2c_f32_bf16_dpp v28, v12, v78 row_newbcast:3 row_mask:0xf bank_mask:0xf
  v_dot2c_f32_bf16_dpp v29, v20, v78 row_newbcast:3 row_mask:0xf bank_mask:0xf
  v_dot2c_f32_bf16_dpp v30, v12, v79 row_newbcast:3 row_mask:0xf bank_mask:0xf
  v_dot2c_f32_bf16_dpp v31, v20, v79 row_newbcast:3 row_mask:0xf bank_mask:0xf
  s_add_u32 s58, s23, 19456
  s_and_b32 s58, s58, 0xffff
  buffer_load_dwordx4 v[76:79], v4, s[28:31], s58 offen nt
  s_waitcnt vmcnt(12)
  v_dot2c_f32_bf16_dpp v24, v12, v80 row_newbcast:4 row_mask:0xf bank_mask:0xf
  v_dot2c_f32_bf16_dpp v25, v20, v80 row_newbcast:4 row_mask:0xf bank_mask:0xf
  v_dot2c_f32_bf16_dpp v26, v12, v81 row_newbcast:4 row_mask:0xf bank_mask:0xf
  v_dot2c_f32_bf16_dpp v27, v20, v81 row_newbcast:4 row_mask:0xf bank_mask:0xf
  v_dot2c_f32_bf16_dpp v28, v12, v82 row_newbcast:4 row_mask:0xf bank_mask:0xf
  v_dot2c_f32_bf16_dpp v29, v20, v82 row_newbcast:4 row_mask:0xf bank_mask:0xf
  v_dot2c_f32_bf16_dpp v30, v12, v83 row_newbcast:4 row_mask:0xf bank_mask:0xf
  v_dot2c_f32_bf16_dpp v31, v20, v83 row_newbcast:4 row_mask:0xf bank_mask:0xf
  s_add_u32 s58, s23, 20480
  s_and_b32 s58, s58, 0xffff
  buffer_load_dwordx4 v[80:83], v4, s[28:31], s58 offen nt
  v_dot2c_f32_bf16_dpp v24, v12, v84 row_newbcast:5 row_mask:0xf bank_mask:0xf
  v_dot2c_f32_bf16_dpp v25, v20, v84 row_newbcast:5 row_mask:0xf bank_mask:0xf
  v_dot2c_f32_bf16_dpp v26, v12, v85 row_newbcast:5 row_mask:0xf bank_mask:0xf
  v_dot2c_f32_bf16_dpp v27, v20, v85 row_newbcast:5 row_mask:0xf bank_mask:0xf
  v_dot2c_f32_bf16_dpp v28, v12, v86 row_newbcast:5 row_mask:0xf bank_mask:0xf
  v_dot2c_f32_bf16_dpp v29, v20, v86 row_newbcast:5 row_mask:0xf bank_mask:0xf
  v_dot2c_f32_bf16_dpp v30, v12, v87 row_newbcast:5 row_mask:0xf bank_mask:0xf
  v_dot2c_f32_bf16_dpp v31, v20, v87 row_newbcast:5 row_mask:0xf bank_mask:0xf
  s_add_u32 s58, s23, 21504
  s_and_b32 s58, s58, 0xffff
  buffer_load_dwordx4 v[84:87], v4, s[28:31], s58 offen nt
  v_dot2c_f32_bf16_dpp v24, v12, v88 row_newbcast:6 row_mask:0xf bank_mask:0xf
  v_dot2c_f32_bf16_dpp v25, v20, v88 row_newbcast:6 row_mask:0xf bank_mask:0xf
  v_dot2c_f32_bf16_dpp v26, v12, v89 row_newbcast:6 row_mask:0xf bank_mask:0xf
  v_dot2c_f32_bf16_dpp v27, v20, v89 row_newbcast:6 row_mask:0xf bank_mask:0xf
  v_dot2c_f32_bf16_dpp v28, v12, v90 row_newbcast:6 row_mask:0xf bank_mask:0xf
  v_dot2c_f32_bf16_dpp v29, v20, v90 row_newbcast:6 row_mask:0xf bank_mask:0xf
  v_dot2c_f32_bf16_dpp v30, v12, v91 row_newbcast:6 row_mask:0xf bank_mask:0xf
  v_dot2c_f32_bf16_dpp v31, v20, v91 row_newbcast:6 row_mask:0xf bank_mask:0xf
  s_add_u32 s58, s23, 22528
  s_and_b32 s58, s58, 0xffff
  buffer_load_dwordx4 v[88:91], v4, s[28:31], s58 offen nt
  v_dot2c_f32_bf16_dpp v24, v12, v92 row_newbcast:7 row_mask:0xf bank_mask:0xf
  v_dot2c_f32_bf16_dpp v25, v20, v92 row_newbcast:7 row_mask:0xf bank_mask:0xf
  v_dot2c_f32_bf16_dpp v26, v12, v93 row_newbcast:7 row_mask:0xf bank_mask:0xf
  v_dot2c_f32_bf16_dpp v27, v20, v93 row_newbcast:7 row_mask:0xf bank_mask:0xf
  v_dot2c_f32_bf16_dpp v28, v12, v94 row_newbcast:7 row_mask:0xf bank_mask:0xf
  v_dot2c_f32_bf16_dpp v29, v20, v94 row_newbcast:7 row_mask:0xf bank_mask:0xf
  v_dot2c_f32_bf16_dpp v30, v12, v95 row_newbcast:7 row_mask:0xf bank_mask:0xf
  v_dot2c_f32_bf16_dpp v31, v20, v95 row_newbcast:7 row_mask:0xf bank_mask:0xf
  s_add_u32 s58, s23, 23552
  s_and_b32 s58, s58, 0xffff
  buffer_load_dwordx4 v[92:95], v4, s[28:31], s58 offen nt
  s_waitcnt vmcnt(12)
  v_dot2c_f32_bf16_dpp v24, v12, v96 row_newbcast:8 row_mask:0xf bank_mask:0xf
  v_dot2c_f32_bf16_dpp v25, v20, v96 row_newbcast:8 row_mask:0xf bank_mask:0xf
  v_dot2c_f32_bf16_dpp v26, v12, v97 row_newbcast:8 row_mask:0xf bank_mask:0xf
  v_dot2c_f32_bf16_dpp v27, v20, v97 row_newbcast:8 row_mask:0xf bank_mask:0xf
  v_dot2c_f32_bf16_dpp v28, v12, v98 row_newbcast:8 row_mask:0xf bank_mask:0xf
  v_dot2c_f32_bf16_dpp v29, v20, v98 row_newbcast:8 row_mask:0xf bank_mask:0xf
  v_dot2c_f32_bf16_dpp v30, v12, v99 row_newbcast:8 row_mask:0xf bank_mask:0xf
  v_dot2c_f32_bf16_dpp v31, v20, v99 row_newbcast:8 row_mask:0xf bank_mask:0xf
  s_add_u32 s58, s23, 24576
  s_and_b32 s58, s58, 0xffff
  buffer_load_dwordx4 v[96:99], v4, s[28:31], s58 offen nt
  v_dot2c_f32_bf16_dpp v24, v12, v100 row_newbcast:9 row_mask:0xf bank_mask:0xf
  v_dot2c_f32_bf16_dpp v25, v20, v100 row_newbcast:9 row_mask:0xf bank_mask:0xf
  v_dot2c_f32_bf16_dpp v26, v12, v101 row_newbcast:9 row_mask:0xf bank_mask:0xf
  v_dot2c_f32_bf16_dpp v27, v20, v101 row_newbcast:9 row_mask:0xf bank_mask:0xf
  v_dot2c_f32_bf16_dpp v28, v12, v102 row_newbcast:9 row_mask:0xf bank_mask:0xf
  v_dot2c_f32_bf16_dpp v29, v20, v102 row_newbcast:9 row_mask:0xf bank_mask:0xf
  v_dot2c_f32_bf16_dpp v30, v12, v103 row_newbcast:9 row_mask:0xf bank_mask:0xf
  v_dot2c_f32_bf16_dpp v31, v20, v103 row_newbcast:9 row_mask:0xf bank_mask:0xf
  s_add_u32 s58, s23, 25600
  s_and_b32 s58, s58, 0xffff
  buffer_load_dwordx4 v[100:103], v4, s[28:31], s58 offen nt
  v_dot2c_f32_bf16_dpp v24, v12, v104 row_newbcast:10 row_mask:0xf bank_mask:0xf
  v_dot2c_f32_bf16_dpp v25, v20, v104 row_newbcast:10 row_mask:0xf bank_mask:0xf
  v_dot2c_f32_bf16_dpp v26, v12, v105 row_newbcast:10 row_mask:0xf bank_mask:0xf
  v_dot2c_f32_bf16_dpp v27, v20, v105 row_newbcast:10 row_mask:0xf bank_mask:0xf
  v_dot2c_f32_bf16_dpp v28, v12, v106 row_newbcast:10 row_mask:0xf bank_mask:0xf
  v_dot2c_f32_bf16_dpp v29, v20, v106 row_newbcast:10 row_mask:0xf bank_mask:0xf
  v_dot2c_f32_bf16_dpp v30, v12, v107 row_newbcast:10 row_mask:0xf bank_mask:0xf
  v_dot2c_f32_bf16_dpp v31, v20, v107 row_newbcast:10 row_mask:0xf bank_mask:0xf
  s_add_u32 s58, s23, 26624
  s_and_b32 s58, s58, 0xffff
  buffer_load_dwordx4 v[104:107], v4, s[28:31], s58 offen nt
  v_dot2c_f32_bf16_dpp v24, v12, v108 row_newbcast:11 row_mask:0xf bank_mask:0xf
  v_dot2c_f32_bf16_dpp v25, v20, v108 row_newbcast:11 row_mask:0xf bank_mask:0xf
  v_dot2c_f32_bf16_dpp v26, v12, v109 row_newbcast:11 row_mask:0xf bank_mask:0xf
  v_dot2c_f32_bf16_dpp v27, v20, v109 row_newbcast:11 row_mask:0xf bank_mask:0xf
  v_dot2c_f32_bf16_dpp v28, v12, v110 row_newbcast:11 row_mask:0xf bank_mask:0xf
  v_dot2c_f32_bf16_dpp v29, v20, v110 row_newbcast:11 row_mask:0xf bank_mask:0xf
  v_dot2c_f32_bf16_dpp v30, v12, v111 row_newbcast:11 row_mask:0xf bank_mask:0xf
  v_dot2c_f32_bf16_dpp v31, v20, v111 row_newbcast:11 row_mask:0xf bank_mask:0xf
  s_add_u32 s58, s23, 27648
  s_and_b32 s58, s58, 0xffff
  buffer_load_dwordx4 v[108:111], v4, s[28:31], s58 offen nt
  s_waitcnt vmcnt(12)
  v_dot2c_f32_bf16_dpp v24, v12, v112 row_newbcast:12 row_mask:0xf bank_mask:0xf
  v_dot2c_f32_bf16_dpp v25, v20, v112 row_newbcast:12 row_mask:0xf bank_mask:0xf
  v_dot2c_f32_bf16_dpp v26, v12, v113 row_newbcast:12 row_mask:0xf bank_mask:0xf
  v_dot2c_f32_bf16_dpp v27, v20, v113 row_newbcast:12 row_mask:0xf bank_mask:0xf
  v_dot2c_f32_bf16_dpp v28, v12, v114 row_newbcast:12 row_mask:0xf bank_mask:0xf
  v_dot2c_f32_bf16_dpp v29, v20, v114 row_newbcast:12 row_mask:0xf bank_mask:0xf
  v_dot2c_f32_bf16_dpp v30, v12, v115 row_newbcast:12 row_mask:0xf bank_mask:0xf
  v_dot2c_f32_bf16_dpp v31, v20, v115 row_newbcast:12 row_mask:0xf bank_mask:0xf
  s_add_u32 s58, s23, 28672
  s_and_b32 s58, s58, 0xffff
  buffer_load_dwordx4 v[112:115], v4, s[28:31], s58 offen nt
  v_dot2c_f32_bf16_dpp v24, v12, v116 row_newbcast:13 row_mask:0xf bank_mask:0xf
  v_dot2c_f32_bf16_dpp v25, v20, v116 row_newbcast:13 row_mask:0xf bank_mask:0xf
  v_dot2c_f32_bf16_dpp v26, v12, v117 row_newbcast:13 row_mask:0xf bank_mask:0xf
  v_dot2c_f32_bf16_dpp v27, v20, v117 row_newbcast:13 row_mask:0xf bank_mask:0xf
  v_dot2c_f32_bf16_dpp v28, v12, v118 row_newbcast:13 row_mask:0xf bank_mask:0xf
  v_dot2c_f32_bf16_dpp v29, v20, v118 row_newbcast:13 row_mask:0xf bank_mask:0xf
  v_dot2c_f32_bf16_dpp v30, v12, v119 row_newbcast:13 row_mask:0xf bank_mask:0xf
  v_dot2c_f32_bf16_dpp v31, v20, v119 row_newbcast:13 row_mask:0xf bank_mask:0xf
  s_add_u32 s58, s23, 29696
  s_and_b32 s58, s58, 0xffff
  buffer_load_dwordx4 v[116:119], v4, s[28:31], s58 offen nt
  v_dot2c_f32_bf16_dpp v24, v12, v120 row_newbcast:14 row_mask:0xf bank_mask:0xf
  v_dot2c_f32_bf16_dpp v25, v20, v120 row_newbcast:14 row_mask:0xf bank_mask:0xf
  v_dot2c_f32_bf16_dpp v26, v12, v121 row_newbcast:14 row_mask:0xf bank_mask:0xf
  v_dot2c_f32_bf16_dpp v27, v20, v121 row_newbcast:14 row_mask:0xf bank_mask:0xf
  v_dot2c_f32_bf16_dpp v28, v12, v122 row_newbcast:14 row_mask:0xf bank_mask:0xf
  v_dot2c_f32_bf16_dpp v29, v20, v122 row_newbcast:14 row_mask:0xf bank_mask:0xf
  v_dot2c_f32_bf16_dpp v30, v12, v123 row_newbcast:14 row_mask:0xf bank_mask:0xf
  v_dot2c_f32_bf16_dpp v31, v20, v123 row_newbcast:14 row_mask:0xf bank_mask:0xf
  s_add_u32 s58, s23, 30720
  s_and_b32 s58, s58, 0xffff
  buffer_load_dwordx4 v[120:123], v4, s[28:31], s58 offen nt
  v_dot2c_f32_bf16_dpp v24, v12, v124 row_newbcast:15 row_mask:0xf bank_mask:0xf
  v_dot2c_f32_bf16_dpp v25, v20, v124 row_newbcast:15 row_mask:0xf bank_mask:0xf
  v_dot2c_f32_bf16_dpp v26, v12, v125 row_newbcast:15 row_mask:0xf bank_mask:0xf
  v_dot2c_f32_bf16_dpp v27, v20, v125 row_newbcast:15 row_mask:0xf bank_mask:0xf
  v_dot2c_f32_bf16_dpp v28, v12, v126 row_newbcast:15 row_mask:0xf bank_mask:0xf
  v_dot2c_f32_bf16_dpp v29, v20, v126 row_newbcast:15 row_mask:0xf bank_mask:0xf
  v_dot2c_f32_bf16_dpp v30, v12, v127 row_newbcast:15 row_mask:0xf bank_mask:0xf
  v_dot2c_f32_bf16_dpp v31, v20, v127 row_newbcast:15 row_mask:0xf bank_mask:0xf
  s_add_u32 s58, s23, 31744
  s_and_b32 s58, s58, 0xffff
  buffer_load_dwordx4 v[124:127], v4, s[28:31], s58 offen nt
  s_waitcnt vmcnt(12)
  v_dot2c_f32_bf16_dpp v24, v13, v64 row_newbcast:0 row_mask:0xf bank_mask:0xf
  v_dot2c_f32_bf16_dpp v25, v21, v64 row_newbcast:0 row_mask:0xf bank_mask:0xf
  v_dot2c_f32_bf16_dpp v26, v13, v65 row_newbcast:0 row_mask:0xf bank_mask:0xf
  v_dot2c_f32_bf16_dpp v27, v21, v65 row_newbcast:0 row_mask:0xf bank_mask:0xf
  v_dot2c_f32_bf16_dpp v28, v13, v66 row_newbcast:0 row_mask:0xf bank_mask:0xf
  v_dot2c_f32_bf16_dpp v29, v21, v66 row_newbcast:0 row_mask:0xf bank_mask:0xf
  v_dot2c_f32_bf16_dpp v30, v13, v67 row_newbcast:0 row_mask:0xf bank_mask:0xf
  v_dot2c_f32_bf16_dpp v31, v21, v67 row_newbcast:0 row_mask:0xf bank_mask:0xf
  s_add_u32 s58, s23, 32768
  s_and_b32 s58, s58, 0xffff
  buffer_load_dwordx4 v[64:67], v4, s[28:31], s58 offen nt
  v_dot2c_f32_bf16_dpp v24, v13, v68 row_newbcast:1 row_mask:0xf bank_mask:0xf
  v_dot2c_f32_bf16_dpp v25, v21, v68 row_newbcast:1 row_mask:0xf bank_mask:0xf
  v_dot2c_f32_bf16_dpp v26, v13, v69 row_newbcast:1 row_mask:0xf bank_mask:0xf
  v_dot2c_f32_bf16_dpp v27, v21, v69 row_newbcast:1 row_mask:0xf bank_mask:0xf
  v_dot2c_f32_bf16_dpp v28, v13, v70 row_newbcast:1 row_mask:0xf bank_mask:0xf
  v_dot2c_f32_bf16_dpp v29, v21, v70 row_newbcast:1 row_mask:0xf bank_mask:0xf
  v_dot2c_f32_bf16_dpp v30, v13, v71 row_newbcast:1 row_mask:0xf bank_mask:0xf
  v_dot2c_f32_bf16_dpp v31, v21, v71 row_newbcast:1 row_mask:0xf bank_mask:0xf
  s_add_u32 s58, s23, 33792
  s_and_b32 s58, s58, 0xffff
  buffer_load_dwordx4 v[68:71], v4, s[28:31], s58 offen nt
  v_dot2c_f32_bf16_dpp v24, v13, v72 row_newbcast:2 row_mask:0xf bank_mask:0xf
  v_dot2c_f32_bf16_dpp v25, v21, v72 row_newbcast:2 row_mask:0xf bank_mask:0xf
  v_dot2c_f32_bf16_dpp v26, v13, v73 row_newbcast:2 row_mask:0xf bank_mask:0xf
  v_dot2c_f32_bf16_dpp v27, v21, v73 row_newbcast:2 row_mask:0xf bank_mask:0xf
  v_dot2c_f32_bf16_dpp v28, v13, v74 row_newbcast:2 row_mask:0xf bank_mask:0xf
  v_dot2c_f32_bf16_dpp v29, v21, v74 row_newbcast:2 row_mask:0xf bank_mask:0xf
  v_dot2c_f32_bf16_dpp v30, v13, v75 row_newbcast:2 row_mask:0xf bank_mask:0xf
  v_dot2c_f32_bf16_dpp v31, v21, v75 row_newbcast:2 row_mask:0xf bank_mask:0xf
  s_add_u32 s58, s23, 34816
  s_and_b32 s58, s58, 0xffff
  buffer_load_dwordx4 v[72:75], v4, s[28:31], s58 offen nt
  v_dot2c_f32_bf16_dpp v24, v13, v76 row_newbcast:3 row_mask:0xf bank_mask:0xf
  v_dot2c_f32_bf16_dpp v25, v21, v76 row_newbcast:3 row_mask:0xf bank_mask:0xf
  v_dot2c_f32_bf16_dpp v26, v13, v77 row_newbcast:3 row_mask:0xf bank_mask:0xf
  v_dot2c_f32_bf16_dpp v27, v21, v77 row_newbcast:3 row_mask:0xf bank_mask:0xf
  v_dot2c_f32_bf16_dpp v28, v13, v78 row_newbcast:3 row_mask:0xf bank_mask:0xf
  v_dot2c_f32_bf16_dpp v29, v21, v78 row_newbcast:3 row_mask:0xf bank_mask:0xf
  v_dot2c_f32_bf16_dpp v30, v13, v79 row_newbcast:3 row_mask:0xf bank_mask:0xf
  v_dot2c_f32_bf16_dpp v31, v21, v79 row_newbcast:3 row_mask:0xf bank_mask:0xf
  s_add_u32 s58, s23, 35840
  s_and_b32 s58, s58, 0xffff
  buffer_load_dwordx4 v[76:79], v4, s[28:31], s58 offen nt
  s_waitcnt vmcnt(12)
  v_dot2c_f32_bf16_dpp v24, v13, v80 row_newbcast:4 row_mask:0xf bank_mask:0xf
  v_dot2c_f32_bf16_dpp v25, v21, v80 row_newbcast:4 row_mask:0xf bank_mask:0xf
  v_dot2c_f32_bf16_dpp v26, v13, v81 row_newbcast:4 row_mask:0xf bank_mask:0xf
  v_dot2c_f32_bf16_dpp v27, v21, v81 row_newbcast:4 row_mask:0xf bank_mask:0xf
  v_dot2c_f32_bf16_dpp v28, v13, v82 row_newbcast:4 row_mask:0xf bank_mask:0xf
  v_dot2c_f32_bf16_dpp v29, v21, v82 row_newbcast:4 row_mask:0xf bank_mask:0xf
  v_dot2c_f32_bf16_dpp v30, v13, v83 row_newbcast:4 row_mask:0xf bank_mask:0xf
  v_dot2c_f32_bf16_dpp v31, v21, v83 row_newbcast:4 row_mask:0xf bank_mask:0xf
  s_add_u32 s58, s23, 36864
  s_and_b32 s58, s58, 0xffff
  buffer_load_dwordx4 v[80:83], v4, s[28:31], s58 offen nt
  v_dot2c_f32_bf16_dpp v24, v13, v84 row_newbcast:5 row_mask:0xf bank_mask:0xf
  v_dot2c_f32_bf16_dpp v25, v21, v84 row_newbcast:5 row_mask:0xf bank_mask:0xf
  v_dot2c_f32_bf16_dpp v26, v13, v85 row_newbcast:5 row_mask:0xf bank_mask:0xf
  v_dot2c_f32_bf16_dpp v27, v21, v85 row_newbcast:5 row_mask:0xf bank_mask:0xf
  v_dot2c_f32_bf16_dpp v28, v13, v86 row_newbcast:5 row_mask:0xf bank_mask:0xf
  v_dot2c_f32_bf16_dpp v29, v21, v86 row_newbcast:5 row_mask:0xf bank_mask:0xf
  v_dot2c_f32_bf16_dpp v30, v13, v87 row_newbcast:5 row_mask:0xf bank_mask:0xf
  v_dot2c_f32_bf16_dpp v31, v21, v87 row_newbcast:5 row_mask:0xf bank_mask:0xf
  s_add_u32 s58, s23, 37888
  s_and_b32 s58, s58, 0xffff
  buffer_load_dwordx4 v[84:87], v4, s[28:31], s58 offen nt
  v_dot2c_f32_bf16_dpp v24, v13, v88 row_newbcast:6 row_mask:0xf bank_mask:0xf
  v_dot2c_f32_bf16_dpp v25, v21, v88 row_newbcast:6 row_mask:0xf bank_mask:0xf
  v_dot2c_f32_bf16_dpp v26, v13, v89 row_newbcast:6 row_mask:0xf bank_mask:0xf
  v_dot2c_f32_bf16_dpp v27, v21, v89 row_newbcast:6 row_mask:0xf bank_mask:0xf
  v_dot2c_f32_bf16_dpp v28, v13, v90 row_newbcast:6 row_mask:0xf bank_mask:0xf
  v_dot2c_f32_bf16_dpp v29, v21, v90 row_newbcast:6 row_mask:0xf bank_mask:0xf
  v_dot2c_f32_bf16_dpp v30, v13, v91 row_newbcast:6 row_mask:0xf bank_mask:0xf
  v_dot2c_f32_bf16_dpp v31, v21, v91 row_newbcast:6 row_mask:0xf bank_mask:0xf
  s_add_u32 s58, s23, 38912
  s_and_b32 s58, s58, 0xffff
  buffer_load_dwordx4 v[88:91], v4, s[28:31], s58 offen nt
  v_dot2c_f32_bf16_dpp v24, v13, v92 row_newbcast:7 row_mask:0xf bank_mask:0xf
  v_dot2c_f32_bf16_dpp v25, v21, v92 row_newbcast:7 row_mask:0xf bank_mask:0xf
  v_dot2c_f32_bf16_dpp v26, v13, v93 row_newbcast:7 row_mask:0xf bank_mask:0xf
  v_dot2c_f32_bf16_dpp v27, v21, v93 row_newbcast:7 row_mask:0xf bank_mask:0xf
  v_dot2c_f32_bf16_dpp v28, v13, v94 row_newbcast:7 row_mask:0xf bank_mask:0xf
  v_dot2c_f32_bf16_dpp v29, v21, v94 row_newbcast:7 row_mask:0xf bank_mask:0xf
  v_dot2c_f32_bf16_dpp v30, v13, v95 row_newbcast:7 row_mask:0xf bank_mask:0xf
  v_dot2c_f32_bf16_dpp v31, v21, v95 row_newbcast:7 row_mask:0xf bank_mask:0xf
  s_add_u32 s58, s23, 39936
  s_and_b32 s58, s58, 0xffff
  buffer_load_dwordx4 v[92:95], v4, s[28:31], s58 offen nt
  s_waitcnt vmcnt(12)
  v_dot2c_f32_bf16_dpp v24, v13, v96 row_newbcast:8 row_mask:0xf bank_mask:0xf
  v_dot2c_f32_bf16_dpp v25, v21, v96 row_newbcast:8 row_mask:0xf bank_mask:0xf
  v_dot2c_f32_bf16_dpp v26, v13, v97 row_newbcast:8 row_mask:0xf bank_mask:0xf
  v_dot2c_f32_bf16_dpp v27, v21, v97 row_newbcast:8 row_mask:0xf bank_mask:0xf
  v_dot2c_f32_bf16_dpp v28, v13, v98 row_newbcast:8 row_mask:0xf bank_mask:0xf
  v_dot2c_f32_bf16_dpp v29, v21, v98 row_newbcast:8 row_mask:0xf bank_mask:0xf
  v_dot2c_f32_bf16_dpp v30, v13, v99 row_newbcast:8 row_mask:0xf bank_mask:0xf
  v_dot2c_f32_bf16_dpp v31, v21, v99 row_newbcast:8 row_mask:0xf bank_mask:0xf
  s_add_u32 s58, s23, 40960
  s_and_b32 s58, s58, 0xffff
  buffer_load_dwordx4 v[96:99], v4, s[28:31], s58 offen nt
  v_dot2c_f32_bf16_dpp v24, v13, v100 row_newbcast:9 row_mask:0xf bank_mask:0xf
  v_dot2c_f32_bf16_dpp v25, v21, v100 row_newbcast:9 row_mask:0xf bank_mask:0xf
  v_dot2c_f32_bf16_dpp v26, v13, v101 row_newbcast:9 row_mask:0xf bank_mask:0xf
  v_dot2c_f32_bf16_dpp v27, v21, v101 row_newbcast:9 row_mask:0xf bank_mask:0xf
  v_dot2c_f32_bf16_dpp v28, v13, v102 row_newbcast:9 row_mask:0xf bank_mask:0xf
  v_dot2c_f32_bf16_dpp v29, v21, v102 row_newbcast:9 row_mask:0xf bank_mask:0xf
  v_dot2c_f32_bf16_dpp v30, v13, v103 row_newbcast:9 row_mask:0xf bank_mask:0xf
  v_dot2c_f32_bf16_dpp v31, v21, v103 row_newbcast:9 row_mask:0xf bank_mask:0xf
  s_add_u32 s58, s23, 41984
  s_and_b32 s58, s58, 0xffff
  buffer_load_dwordx4 v[100:103], v4, s[28:31], s58 offen nt
  v_dot2c_f32_bf16_dpp v24, v13, v104 row_newbcast:10 row_mask:0xf bank_mask:0xf
  v_dot2c_f32_bf16_dpp v25, v21, v104 row_newbcast:10 row_mask:0xf bank_mask:0xf
  v_dot2c_f32_bf16_dpp v26, v13, v105 row_newbcast:10 row_mask:0xf bank_mask:0xf
  v_dot2c_f32_bf16_dpp v27, v21, v105 row_newbcast:10 row_mask:0xf bank_mask:0xf
  v_dot2c_f32_bf16_dpp v28, v13, v106 row_newbcast:10 row_mask:0xf bank_mask:0xf
  v_dot2c_f32_bf16_dpp v29, v21, v106 row_newbcast:10 row_mask:0xf bank_mask:0xf
  v_dot2c_f32_bf16_dpp v30, v13, v107 row_newbcast:10 row_mask:0xf bank_mask:0xf
  v_dot2c_f32_bf16_dpp v31, v21, v107 row_newbcast:10 row_mask:0xf bank_mask:0xf
  s_add_u32 s58, s23, 43008
  s_and_b32 s58, s58, 0xffff
  buffer_load_dwordx4 v[104:107], v4, s[28:31], s58 offen nt
  v_dot2c_f32_bf16_dpp v24, v13, v108 row_newbcast:11 row_mask:0xf bank_mask:0xf
  v_dot2c_f32_bf16_dpp v25, v21, v108 row_newbcast:11 row_mask:0xf bank_mask:0xf
  v_dot2c_f32_bf16_dpp v26, v13, v109 row_newbcast:11 row_mask:0xf bank_mask:0xf
  v_dot2c_f32_bf16_dpp v27, v21, v109 row_newbcast:11 row_mask:0xf bank_mask:0xf
  v_dot2c_f32_bf16_dpp v28, v13, v110 row_newbcast:11 row_mask:0xf bank_mask:0xf
  v_dot2c_f32_bf16_dpp v29, v21, v110 row_newbcast:11 row_mask:0xf bank_mask:0xf
  v_dot2c_f32_bf16_dpp v30, v13, v111 row_newbcast:11 row_mask:0xf bank_mask:0xf
  v_dot2c_f32_bf16_dpp v31, v21, v111 row_newbcast:11 row_mask:0xf bank_mask:0xf
  s_add_u32 s58, s23, 44032
  s_and_b32 s58, s58, 0xffff
  buffer_load_dwordx4 v[108:111], v4, s[28:31], s58 offen nt
  s_waitcnt vmcnt(12)
  v_dot2c_f32_bf16_dpp v24, v13, v112 row_newbcast:12 row_mask:0xf bank_mask:0xf
  v_dot2c_f32_bf16_dpp v25, v21, v112 row_newbcast:12 row_mask:0xf bank_mask:0xf
  v_dot2c_f32_bf16_dpp v26, v13, v113 row_newbcast:12 row_mask:0xf bank_mask:0xf
  v_dot2c_f32_bf16_dpp v27, v21, v113 row_newbcast:12 row_mask:0xf bank_mask:0xf
  v_dot2c_f32_bf16_dpp v28, v13, v114 row_newbcast:12 row_mask:0xf bank_mask:0xf
  v_dot2c_f32_bf16_dpp v29, v21, v114 row_newbcast:12 row_mask:0xf bank_mask:0xf
  v_dot2c_f32_bf16_dpp v30, v13, v115 row_newbcast:12 row_mask:0xf bank_mask:0xf
  v_dot2c_f32_bf16_dpp v31, v21, v115 row_newbcast:12 row_mask:0xf bank_mask:0xf
  s_add_u32 s58, s23, 45056
  s_and_b32 s58, s58, 0xffff
  buffer_load_dwordx4 v[112:115], v4, s[28:31], s58 offen nt
  v_dot2c_f32_bf16_dpp v24, v13, v116 row_newbcast:13 row_mask:0xf bank_mask:0xf
  v_dot2c_f32_bf16_dpp v25, v21, v116 row_newbcast:13 row_mask:0xf bank_mask:0xf
  v_dot2c_f32_bf16_dpp v26, v13, v117 row_newbcast:13 row_mask:0xf bank_mask:0xf
  v_dot2c_f32_bf16_dpp v27, v21, v117 row_newbcast:13 row_mask:0xf bank_mask:0xf
  v_dot2c_f32_bf16_dpp v28, v13, v118 row_newbcast:13 row_mask:0xf bank_mask:0xf
  v_dot2c_f32_bf16_dpp v29, v21, v118 row_newbcast:13 row_mask:0xf bank_mask:0xf
  v_dot2c_f32_bf16_dpp v30, v13, v119 row_newbcast:13 row_mask:0xf bank_mask:0xf
  v_dot2c_f32_bf16_dpp v31, v21, v119 row_newbcast:13 row_mask:0xf bank_mask:0xf
  s_add_u32 s58, s23, 46080
  s_and_b32 s58, s58, 0xffff
  buffer_load_dwordx4 v[116:119], v4, s[28:31], s58 offen nt
  v_dot2c_f32_bf16_dpp v24, v13, v120 row_newbcast:14 row_mask:0xf bank_mask:0xf
  v_dot2c_f32_bf16_dpp v25, v21, v120 row_newbcast:14 row_mask:0xf bank_mask:0xf
  v_dot2c_f32_bf16_dpp v26, v13, v121 row_newbcast:14 row_mask:0xf bank_mask:0xf
  v_dot2c_f32_bf16_dpp v27, v21, v121 row_newbcast:14 row_mask:0xf bank_mask:0xf
  v_dot2c_f32_bf16_dpp v28, v13, v122 row_newbcast:14 row_mask:0xf bank_mask:0xf
  v_dot2c_f32_bf16_dpp v29, v21, v122 row_newbcast:14 row_mask:0xf bank_mask:0xf
  v_dot2c_f32_bf16_dpp v30, v13, v123 row_newbcast:14 row_mask:0xf bank_mask:0xf
  v_dot2c_f32_bf16_dpp v31, v21, v123 row_newbcast:14 row_mask:0xf bank_mask:0xf
  s_add_u32 s58, s23, 47104
  s_and_b32 s58, s58, 0xffff
  buffer_load_dwordx4 v[120:123], v4, s[28:31], s58 offen nt
  v_dot2c_f32_bf16_dpp v24, v13, v124 row_newbcast:15 row_mask:0xf bank_mask:0xf
  v_dot2c_f32_bf16_dpp v25, v21, v124 row_newbcast:15 row_mask:0xf bank_mask:0xf
  v_dot2c_f32_bf16_dpp v26, v13, v125 row_newbcast:15 row_mask:0xf bank_mask:0xf
  v_dot2c_f32_bf16_dpp v27, v21, v125 row_newbcast:15 row_mask:0xf bank_mask:0xf
  v_dot2c_f32_bf16_dpp v28, v13, v126 row_newbcast:15 row_mask:0xf bank_mask:0xf
  v_dot2c_f32_bf16_dpp v29, v21, v126 row_newbcast:15 row_mask:0xf bank_mask:0xf
  v_dot2c_f32_bf16_dpp v30, v13, v127 row_newbcast:15 row_mask:0xf bank_mask:0xf
  v_dot2c_f32_bf16_dpp v31, v21, v127 row_newbcast:15 row_mask:0xf bank_mask:0xf
  s_add_u32 s58, s23, 48128
  s_and_b32 s58, s58, 0xffff
  buffer_load_dwordx4 v[124:127], v4, s[28:31], s58 offen nt
  s_waitcnt vmcnt(12)
  v_dot2c_f32_bf16_dpp v24, v14, v64 row_newbcast:0 row_mask:0xf bank_mask:0xf
  v_dot2c_f32_bf16_dpp v25, v22, v64 row_newbcast:0 row_mask:0xf bank_mask:0xf
  v_dot2c_f32_bf16_dpp v26, v14, v65 row_newbcast:0 row_mask:0xf bank_mask:0xf
  v_dot2c_f32_bf16_dpp v27, v22, v65 row_newbcast:0 row_mask:0xf bank_mask:0xf
  v_dot2c_f32_bf16_dpp v28, v14, v66 row_newbcast:0 row_mask:0xf bank_mask:0xf
  v_dot2c_f32_bf16_dpp v29, v22, v66 row_newbcast:0 row_mask:0xf bank_mask:0xf
  v_dot2c_f32_bf16_dpp v30, v14, v67 row_newbcast:0 row_mask:0xf bank_mask:0xf
  v_dot2c_f32_bf16_dpp v31, v22, v67 row_newbcast:0 row_mask:0xf bank_mask:0xf
  s_add_u32 s58, s23, 49152
  s_and_b32 s58, s58, 0xffff
  buffer_load_dwordx4 v[64:67], v4, s[28:31], s58 offen nt
  v_dot2c_f32_bf16_dpp v24, v14, v68 row_newbcast:1 row_mask:0xf bank_mask:0xf
  v_dot2c_f32_bf16_dpp v25, v22, v68 row_newbcast:1 row_mask:0xf bank_mask:0xf
  v_dot2c_f32_bf16_dpp v26, v14, v69 row_newbcast:1 row_mask:0xf bank_mask:0xf
  v_dot2c_f32_bf16_dpp v27, v22, v69 row_newbcast:1 row_mask:0xf bank_mask:0xf
  v_dot2c_f32_bf16_dpp v28, v14, v70 row_newbcast:1 row_mask:0xf bank_mask:0xf
  v_dot2c_f32_bf16_dpp v29, v22, v70 row_newbcast:1 row_mask:0xf bank_mask:0xf
  v_dot2c_f32_bf16_dpp v30, v14, v71 row_newbcast:1 row_mask:0xf bank_mask:0xf
  v_dot2c_f32_bf16_dpp v31, v22, v71 row_newbcast:1 row_mask:0xf bank_mask:0xf
  s_add_u32 s58, s23, 50176
  s_and_b32 s58, s58, 0xffff
  buffer_load_dwordx4 v[68:71], v4, s[28:31], s58 offen nt
  v_dot2c_f32_bf16_dpp v24, v14, v72 row_newbcast:2 row_mask:0xf bank_mask:0xf
  v_dot2c_f32_bf16_dpp v25, v22, v72 row_newbcast:2 row_mask:0xf bank_mask:0xf
  v_dot2c_f32_bf16_dpp v26, v14, v73 row_newbcast:2 row_mask:0xf bank_mask:0xf
  v_dot2c_f32_bf16_dpp v27, v22, v73 row_newbcast:2 row_mask:0xf bank_mask:0xf
  v_dot2c_f32_bf16_dpp v28, v14, v74 row_newbcast:2 row_mask:0xf bank_mask:0xf
  v_dot2c_f32_bf16_dpp v29, v22, v74 row_newbcast:2 row_mask:0xf bank_mask:0xf
  v_dot2c_f32_bf16_dpp v30, v14, v75 row_newbcast:2 row_mask:0xf bank_mask:0xf
  v_dot2c_f32_bf16_dpp v31, v22, v75 row_newbcast:2 row_mask:0xf bank_mask:0xf
  s_add_u32 s58, s23, 51200
  s_and_b32 s58, s58, 0xffff
  buffer_load_dwordx4 v[72:75], v4, s[28:31], s58 offen nt
  v_dot2c_f32_bf16_dpp v24, v14, v76 row_newbcast:3 row_mask:0xf bank_mask:0xf
  v_dot2c_f32_bf16_dpp v25, v22, v76 row_newbcast:3 row_mask:0xf bank_mask:0xf
  v_dot2c_f32_bf16_dpp v26, v14, v77 row_newbcast:3 row_mask:0xf bank_mask:0xf
  v_dot2c_f32_bf16_dpp v27, v22, v77 row_newbcast:3 row_mask:0xf bank_mask:0xf
  v_dot2c_f32_bf16_dpp v28, v14, v78 row_newbcast:3 row_mask:0xf bank_mask:0xf
  v_dot2c_f32_bf16_dpp v29, v22, v78 row_newbcast:3 row_mask:0xf bank_mask:0xf
  v_dot2c_f32_bf16_dpp v30, v14, v79 row_newbcast:3 row_mask:0xf bank_mask:0xf
  v_dot2c_f32_bf16_dpp v31, v22, v79 row_newbcast:3 row_mask:0xf bank_mask:0xf
  s_add_u32 s58, s23, 52224
  s_and_b32 s58, s58, 0xffff
  buffer_load_dwordx4 v[76:79], v4, s[28:31], s58 offen nt
  s_waitcnt vmcnt(12)
  v_dot2c_f32_bf16_dpp v24, v14, v80 row_newbcast:4 row_mask:0xf bank_mask:0xf
  v_dot2c_f32_bf16_dpp v25, v22, v80 row_newbcast:4 row_mask:0xf bank_mask:0xf
  v_dot2c_f32_bf16_dpp v26, v14, v81 row_newbcast:4 row_mask:0xf bank_mask:0xf
  v_dot2c_f32_bf16_dpp v27, v22, v81 row_newbcast:4 row_mask:0xf bank_mask:0xf
  v_dot2c_f32_bf16_dpp v28, v14, v82 row_newbcast:4 row_mask:0xf bank_mask:0xf
  v_dot2c_f32_bf16_dpp v29, v22, v82 row_newbcast:4 row_mask:0xf bank_mask:0xf
  v_dot2c_f32_bf16_dpp v30, v14, v83 row_newbcast:4 row_mask:0xf bank_mask:0xf
  v_dot2c_f32_bf16_dpp v31, v22, v83 row_newbcast:4 row_mask:0xf bank_mask:0xf
  s_add_u32 s58, s23, 53248
  s_and_b32 s58, s58, 0xffff
  buffer_load_dwordx4 v[80:83], v4, s[28:31], s58 offen nt
  v_dot2c_f32_bf16_dpp v24, v14, v84 row_newbcast:5 row_mask:0xf bank_mask:0xf
  v_dot2c_f32_bf16_dpp v25, v22, v84 row_newbcast:5 row_mask:0xf bank_mask:0xf
  v_dot2c_f32_bf16_dpp v26, v14, v85 row_newbcast:5 row_mask:0xf bank_mask:0xf
  v_dot2c_f32_bf16_dpp v27, v22, v85 row_newbcast:5 row_mask:0xf bank_mask:0xf
  v_dot2c_f32_bf16_dpp v28, v14, v86 row_newbcast:5 row_mask:0xf bank_mask:0xf
  v_dot2c_f32_bf16_dpp v29, v22, v86 row_newbcast:5 row_mask:0xf bank_mask:0xf
  v_dot2c_f32_bf16_dpp v30, v14, v87 row_newbcast:5 row_mask:0xf bank_mask:0xf
  v_dot2c_f32_bf16_dpp v31, v22, v87 row_newbcast:5 row_mask:0xf bank_mask:0xf
  s_add_u32 s58, s23, 54272
  s_and_b32 s58, s58, 0xffff
  buffer_load_dwordx4 v[84:87], v4, s[28:31], s58 offen nt
  v_dot2c_f32_bf16_dpp v24, v14, v88 row_newbcast:6 row_mask:0xf bank_mask:0xf
  v_dot2c_f32_bf16_dpp v25, v22, v88 row_newbcast:6 row_mask:0xf bank_mask:0xf
  v_dot2c_f32_bf16_dpp v26, v14, v89 row_newbcast:6 row_mask:0xf bank_mask:0xf
  v_dot2c_f32_bf16_dpp v27, v22, v89 row_newbcast:6 row_mask:0xf bank_mask:0xf
  v_dot2c_f32_bf16_dpp v28, v14, v90 row_newbcast:6 row_mask:0xf bank_mask:0xf
  v_dot2c_f32_bf16_dpp v29, v22, v90 row_newbcast:6 row_mask:0xf bank_mask:0xf
  v_dot2c_f32_bf16_dpp v30, v14, v91 row_newbcast:6 row_mask:0xf bank_mask:0xf
  v_dot2c_f32_bf16_dpp v31, v22, v91 row_newbcast:6 row_mask:0xf bank_mask:0xf
  s_add_u32 s58, s23, 55296
  s_and_b32 s58, s58, 0xffff
  buffer_load_dwordx4 v[88:91], v4, s[28:31], s58 offen nt
  v_dot2c_f32_bf16_dpp v24, v14, v92 row_newbcast:7 row_mask:0xf bank_mask:0xf
  v_dot2c_f32_bf16_dpp v25, v22, v92 row_newbcast:7 row_mask:0xf bank_mask:0xf
  v_dot2c_f32_bf16_dpp v26, v14, v93 row_newbcast:7 row_mask:0xf bank_mask:0xf
  v_dot2c_f32_bf16_dpp v27, v22, v93 row_newbcast:7 row_mask:0xf bank_mask:0xf
  v_dot2c_f32_bf16_dpp v28, v14, v94 row_newbcast:7 row_mask:0xf bank_mask:0xf
  v_dot2c_f32_bf16_dpp v29, v22, v94 row_newbcast:7 row_mask:0xf bank_mask:0xf
  v_dot2c_f32_bf16_dpp v30, v14, v95 row_newbcast:7 row_mask:0xf bank_mask:0xf
  v_dot2c_f32_bf16_dpp v31, v22, v95 row_newbcast:7 row_mask:0xf bank_mask:0xf
  s_add_u32 s58, s23, 56320
  s_and_b32 s58, s58, 0xffff
  buffer_load_dwordx4 v[92:95], v4, s[28:31], s58 offen nt
  s_waitcnt vmcnt(12)
  v_dot2c_f32_bf16_dpp v24, v14, v96 row_newbcast:8 row_mask:0xf bank_mask:0xf
  v_dot2c_f32_bf16_dpp v25, v22, v96 row_newbcast:8 row_mask:0xf bank_mask:0xf
  v_dot2c_f32_bf16_dpp v26, v14, v97 row_newbcast:8 row_mask:0xf bank_mask:0xf
  v_dot2c_f32_bf16_dpp v27, v22, v97 row_newbcast:8 row_mask:0xf bank_mask:0xf
  v_dot2c_f32_bf16_dpp v28, v14, v98 row_newbcast:8 row_mask:0xf bank_mask:0xf
  v_dot2c_f32_bf16_dpp v29, v22, v98 row_newbcast:8 row_mask:0xf bank_mask:0xf
  v_dot2c_f32_bf16_dpp v30, v14, v99 row_newbcast:8 row_mask:0xf bank_mask:0xf
  v_dot2c_f32_bf16_dpp v31, v22, v99 row_newbcast:8 row_mask:0xf bank_mask:0xf
  s_add_u32 s58, s23, 57344
  s_and_b32 s58, s58, 0xffff
  buffer_load_dwordx4 v[96:99], v4, s[28:31], s58 offen nt
  v_dot2c_f32_bf16_dpp v24, v14, v100 row_newbcast:9 row_mask:0xf bank_mask:0xf
  v_dot2c_f32_bf16_dpp v25, v22, v100 row_newbcast:9 row_mask:0xf bank_mask:0xf
  v_dot2c_f32_bf16_dpp v26, v14, v101 row_newbcast:9 row_mask:0xf bank_mask:0xf
  v_dot2c_f32_bf16_dpp v27, v22, v101 row_newbcast:9 row_mask:0xf bank_mask:0xf
  v_dot2c_f32_bf16_dpp v28, v14, v102 row_newbcast:9 row_mask:0xf bank_mask:0xf
  v_dot2c_f32_bf16_dpp v29, v22, v102 row_newbcast:9 row_mask:0xf bank_mask:0xf
  v_dot2c_f32_bf16_dpp v30, v14, v103 row_newbcast:9 row_mask:0xf bank_mask:0xf
  v_dot2c_f32_bf16_dpp v31, v22, v103 row_newbcast:9 row_mask:0xf bank_mask:0xf
  s_add_u32 s58, s23, 58368
  s_and_b32 s58, s58, 0xffff
  buffer_load_dwordx4 v[100:103], v4, s[28:31], s58 offen nt
  v_dot2c_f32_bf16_dpp v24, v14, v104 row_newbcast:10 row_mask:0xf bank_mask:0xf
  v_dot2c_f32_bf16_dpp v25, v22, v104 row_newbcast:10 row_mask:0xf bank_mask:0xf
  v_dot2c_f32_bf16_dpp v26, v14, v105 row_newbcast:10 row_mask:0xf bank_mask:0xf
  v_dot2c_f32_bf16_dpp v27, v22, v105 row_newbcast:10 row_mask:0xf bank_mask:0xf
  v_dot2c_f32_bf16_dpp v28, v14, v106 row_newbcast:10 row_mask:0xf bank_mask:0xf
  v_dot2c_f32_bf16_dpp v29, v22, v106 row_newbcast:10 row_mask:0xf bank_mask:0xf
  v_dot2c_f32_bf16_dpp v30, v14, v107 row_newbcast:10 row_mask:0xf bank_mask:0xf
  v_dot2c_f32_bf16_dpp v31, v22, v107 row_newbcast:10 row_mask:0xf bank_mask:0xf
  s_add_u32 s58, s23, 59392
  s_and_b32 s58, s58, 0xffff
  buffer_load_dwordx4 v[104:107], v4, s[28:31], s58 offen nt
  v_dot2c_f32_bf16_dpp v24, v14, v108 row_newbcast:11 row_mask:0xf bank_mask:0xf
  v_dot2c_f32_bf16_dpp v25, v22, v108 row_newbcast:11 row_mask:0xf bank_mask:0xf
  v_dot2c_f32_bf16_dpp v26, v14, v109 row_newbcast:11 row_mask:0xf bank_mask:0xf
  v_dot2c_f32_bf16_dpp v27, v22, v109 row_newbcast:11 row_mask:0xf bank_mask:0xf
  v_dot2c_f32_bf16_dpp v28, v14, v110 row_newbcast:11 row_mask:0xf bank_mask:0xf
  v_dot2c_f32_bf16_dpp v29, v22, v110 row_newbcast:11 row_mask:0xf bank_mask:0xf
  v_dot2c_f32_bf16_dpp v30, v14, v111 row_newbcast:11 row_mask:0xf bank_mask:0xf
  v_dot2c_f32_bf16_dpp v31, v22, v111 row_newbcast:11 row_mask:0xf bank_mask:0xf
  s_add_u32 s58, s23, 60416
  s_and_b32 s58, s58, 0xffff
  buffer_load_dwordx4 v[108:111], v4, s[28:31], s58 offen nt
  s_waitcnt vmcnt(12)
  v_dot2c_f32_bf16_dpp v24, v14, v112 row_newbcast:12 row_mask:0xf bank_mask:0xf
  v_dot2c_f32_bf16_dpp v25, v22, v112 row_newbcast:12 row_mask:0xf bank_mask:0xf
  v_dot2c_f32_bf16_dpp v26, v14, v113 row_newbcast:12 row_mask:0xf bank_mask:0xf
  v_dot2c_f32_bf16_dpp v27, v22, v113 row_newbcast:12 row_mask:0xf bank_mask:0xf
  v_dot2c_f32_bf16_dpp v28, v14, v114 row_newbcast:12 row_mask:0xf bank_mask:0xf
  v_dot2c_f32_bf16_dpp v29, v22, v114 row_newbcast:12 row_mask:0xf bank_mask:0xf
  v_dot2c_f32_bf16_dpp v30, v14, v115 row_newbcast:12 row_mask:0xf bank_mask:0xf
  v_dot2c_f32_bf16_dpp v31, v22, v115 row_newbcast:12 row_mask:0xf bank_mask:0xf
  s_add_u32 s58, s23, 61440
  s_and_b32 s58, s58, 0xffff
  buffer_load_dwordx4 v[112:115], v4, s[28:31], s58 offen nt
  v_dot2c_f32_bf16_dpp v24, v14, v116 row_newbcast:13 row_mask:0xf bank_mask:0xf
  v_dot2c_f32_bf16_dpp v25, v22, v116 row_newbcast:13 row_mask:0xf bank_mask:0xf
  v_dot2c_f32_bf16_dpp v26, v14, v117 row_newbcast:13 row_mask:0xf bank_mask:0xf
  v_dot2c_f32_bf16_dpp v27, v22, v117 row_newbcast:13 row_mask:0xf bank_mask:0xf
  v_dot2c_f32_bf16_dpp v28, v14, v118 row_newbcast:13 row_mask:0xf bank_mask:0xf
  v_dot2c_f32_bf16_dpp v29, v22, v118 row_newbcast:13 row_mask:0xf bank_mask:0xf
  v_dot2c_f32_bf16_dpp v30, v14, v119 row_newbcast:13 row_mask:0xf bank_mask:0xf
  v_dot2c_f32_bf16_dpp v31, v22, v119 row_newbcast:13 row_mask:0xf bank_mask:0xf
  s_add_u32 s58, s23, 62464
  s_and_b32 s58, s58, 0xffff
  buffer_load_dwordx4 v[116:119], v4, s[28:31], s58 offen nt
  v_dot2c_f32_bf16_dpp v24, v14, v120 row_newbcast:14 row_mask:0xf bank_mask:0xf
  v_dot2c_f32_bf16_dpp v25, v22, v120 row_newbcast:14 row_mask:0xf bank_mask:0xf
  v_dot2c_f32_bf16_dpp v26, v14, v121 row_newbcast:14 row_mask:0xf bank_mask:0xf
  v_dot2c_f32_bf16_dpp v27, v22, v121 row_newbcast:14 row_mask:0xf bank_mask:0xf
  v_dot2c_f32_bf16_dpp v28, v14, v122 row_newbcast:14 row_mask:0xf bank_mask:0xf
  v_dot2c_f32_bf16_dpp v29, v22, v122 row_newbcast:14 row_mask:0xf bank_mask:0xf
  v_dot2c_f32_bf16_dpp v30, v14, v123 row_newbcast:14 row_mask:0xf bank_mask:0xf
  v_dot2c_f32_bf16_dpp v31, v22, v123 row_newbcast:14 row_mask:0xf bank_mask:0xf
  s_add_u32 s58, s23, 63488
  s_and_b32 s58, s58, 0xffff
  buffer_load_dwordx4 v[120:123], v4, s[28:31], s58 offen nt
  v_dot2c_f32_bf16_dpp v24, v14, v124 row_newbcast:15 row_mask:0xf bank_mask:0xf
  v_dot2c_f32_bf16_dpp v25, v22, v124 row_newbcast:15 row_mask:0xf bank_mask:0xf
  v_dot2c_f32_bf16_dpp v26, v14, v125 row_newbcast:15 row_mask:0xf bank_mask:0xf
  v_dot2c_f32_bf16_dpp v27, v22, v125 row_newbcast:15 row_mask:0xf bank_mask:0xf
  v_dot2c_f32_bf16_dpp v28, v14, v126 row_newbcast:15 row_mask:0xf bank_mask:0xf
  v_dot2c_f32_bf16_dpp v29, v22, v126 row_newbcast:15 row_mask:0xf bank_mask:0xf
  v_dot2c_f32_bf16_dpp v30, v14, v127 row_newbcast:15 row_mask:0xf bank_mask:0xf
  v_dot2c_f32_bf16_dpp v31, v22, v127 row_newbcast:15 row_mask:0xf bank_mask:0xf
  s_add_u32 s58, s23, 64512
  s_and_b32 s58, s58, 0xffff
  buffer_load_dwordx4 v[124:127], v4, s[28:31], s58 offen nt
  s_waitcnt vmcnt(12)
  v_dot2c_f32_bf16_dpp v24, v15, v64 row_newbcast:0 row_mask:0xf bank_mask:0xf
  v_dot2c_f32_bf16_dpp v25, v23, v64 row_newbcast:0 row_mask:0xf bank_mask:0xf
  v_dot2c_f32_bf16_dpp v26, v15, v65 row_newbcast:0 row_mask:0xf bank_mask:0xf
  v_dot2c_f32_bf16_dpp v27, v23, v65 row_newbcast:0 row_mask:0xf bank_mask:0xf
  v_dot2c_f32_bf16_dpp v28, v15, v66 row_newbcast:0 row_mask:0xf bank_mask:0xf
  v_dot2c_f32_bf16_dpp v29, v23, v66 row_newbcast:0 row_mask:0xf bank_mask:0xf
  v_dot2c_f32_bf16_dpp v30, v15, v67 row_newbcast:0 row_mask:0xf bank_mask:0xf
  v_dot2c_f32_bf16_dpp v31, v23, v67 row_newbcast:0 row_mask:0xf bank_mask:0xf
  v_dot2c_f32_bf16_dpp v24, v15, v68 row_newbcast:1 row_mask:0xf bank_mask:0xf
  v_dot2c_f32_bf16_dpp v25, v23, v68 row_newbcast:1 row_mask:0xf bank_mask:0xf
  v_dot2c_f32_bf16_dpp v26, v15, v69 row_newbcast:1 row_mask:0xf bank_mask:0xf
  v_dot2c_f32_bf16_dpp v27, v23, v69 row_newbcast:1 row_mask:0xf bank_mask:0xf
  v_dot2c_f32_bf16_dpp v28, v15, v70 row_newbcast:1 row_mask:0xf bank_mask:0xf
  v_dot2c_f32_bf16_dpp v29, v23, v70 row_newbcast:1 row_mask:0xf bank_mask:0xf
  v_dot2c_f32_bf16_dpp v30, v15, v71 row_newbcast:1 row_mask:0xf bank_mask:0xf
  v_dot2c_f32_bf16_dpp v31, v23, v71 row_newbcast:1 row_mask:0xf bank_mask:0xf
  v_dot2c_f32_bf16_dpp v24, v15, v72 row_newbcast:2 row_mask:0xf bank_mask:0xf
  v_dot2c_f32_bf16_dpp v25, v23, v72 row_newbcast:2 row_mask:0xf bank_mask:0xf
  v_dot2c_f32_bf16_dpp v26, v15, v73 row_newbcast:2 row_mask:0xf bank_mask:0xf
  v_dot2c_f32_bf16_dpp v27, v23, v73 row_newbcast:2 row_mask:0xf bank_mask:0xf
  v_dot2c_f32_bf16_dpp v28, v15, v74 row_newbcast:2 row_mask:0xf bank_mask:0xf
  v_dot2c_f32_bf16_dpp v29, v23, v74 row_newbcast:2 row_mask:0xf bank_mask:0xf
  v_dot2c_f32_bf16_dpp v30, v15, v75 row_newbcast:2 row_mask:0xf bank_mask:0xf
  v_dot2c_f32_bf16_dpp v31, v23, v75 row_newbcast:2 row_mask:0xf bank_mask:0xf
  v_dot2c_f32_bf16_dpp v24, v15, v76 row_newbcast:3 row_mask:0xf bank_mask:0xf
  v_dot2c_f32_bf16_dpp v25, v23, v76 row_newbcast:3 row_mask:0xf bank_mask:0xf
  v_dot2c_f32_bf16_dpp v26, v15, v77 row_newbcast:3 row_mask:0xf bank_mask:0xf
  v_dot2c_f32_bf16_dpp v27, v23, v77 row_newbcast:3 row_mask:0xf bank_mask:0xf
  v_dot2c_f32_bf16_dpp v28, v15, v78 row_newbcast:3 row_mask:0xf bank_mask:0xf
  v_dot2c_f32_bf16_dpp v29, v23, v78 row_newbcast:3 row_mask:0xf bank_mask:0xf
  v_dot2c_f32_bf16_dpp v30, v15, v79 row_newbcast:3 row_mask:0xf bank_mask:0xf
  v_dot2c_f32_bf16_dpp v31, v23, v79 row_newbcast:3 row_mask:0xf bank_mask:0xf
  s_waitcnt vmcnt(8)
  v_dot2c_f32_bf16_dpp v24, v15, v80 row_newbcast:4 row_mask:0xf bank_mask:0xf
  v_dot2c_f32_bf16_dpp v25, v23, v80 row_newbcast:4 row_mask:0xf bank_mask:0xf
  v_dot2c_f32_bf16_dpp v26, v15, v81 row_newbcast:4 row_mask:0xf bank_mask:0xf
  v_dot2c_f32_bf16_dpp v27, v23, v81 row_newbcast:4 row_mask:0xf bank_mask:0xf
  v_dot2c_f32_bf16_dpp v28, v15, v82 row_newbcast:4 row_mask:0xf bank_mask:0xf
  v_dot2c_f32_bf16_dpp v29, v23, v82 row_newbcast:4 row_mask:0xf bank_mask:0xf
  v_dot2c_f32_bf16_dpp v30, v15, v83 row_newbcast:4 row_mask:0xf bank_mask:0xf
  v_dot2c_f32_bf16_dpp v31, v23, v83 row_newbcast:4 row_mask:0xf bank_mask:0xf
  v_dot2c_f32_bf16_dpp v24, v15, v84 row_newbcast:5 row_mask:0xf bank_mask:0xf
  v_dot2c_f32_bf16_dpp v25, v23, v84 row_newbcast:5 row_mask:0xf bank_mask:0xf
  v_dot2c_f32_bf16_dpp v26, v15, v85 row_newbcast:5 row_mask:0xf bank_mask:0xf
  v_dot2c_f32_bf16_dpp v27, v23, v85 row_newbcast:5 row_mask:0xf bank_mask:0xf
  v_dot2c_f32_bf16_dpp v28, v15, v86 row_newbcast:5 row_mask:0xf bank_mask:0xf
  v_dot2c_f32_bf16_dpp v29, v23, v86 row_newbcast:5 row_mask:0xf bank_mask:0xf
  v_dot2c_f32_bf16_dpp v30, v15, v87 row_newbcast:5 row_mask:0xf bank_mask:0xf
  v_dot2c_f32_bf16_dpp v31, v23, v87 row_newbcast:5 row_mask:0xf bank_mask:0xf
  v_dot2c_f32_bf16_dpp v24, v15, v88 row_newbcast:6 row_mask:0xf bank_mask:0xf
  v_dot2c_f32_bf16_dpp v25, v23, v88 row_newbcast:6 row_mask:0xf bank_mask:0xf
  v_dot2c_f32_bf16_dpp v26, v15, v89 row_newbcast:6 row_mask:0xf bank_mask:0xf
  v_dot2c_f32_bf16_dpp v27, v23, v89 row_newbcast:6 row_mask:0xf bank_mask:0xf
  v_dot2c_f32_bf16_dpp v28, v15, v90 row_newbcast:6 row_mask:0xf bank_mask:0xf
  v_dot2c_f32_bf16_dpp v29, v23, v90 row_newbcast:6 row_mask:0xf bank_mask:0xf
  v_dot2c_f32_bf16_dpp v30, v15, v91 row_newbcast:6 row_mask:0xf bank_mask:0xf
  v_dot2c_f32_bf16_dpp v31, v23, v91 row_newbcast:6 row_mask:0xf bank_mask:0xf
  v_dot2c_f32_bf16_dpp v24, v15, v92 row_newbcast:7 row_mask:0xf bank_mask:0xf
  v_dot2c_f32_bf16_dpp v25, v23, v92 row_newbcast:7 row_mask:0xf bank_mask:0xf
  v_dot2c_f32_bf16_dpp v26, v15, v93 row_newbcast:7 row_mask:0xf bank_mask:0xf
  v_dot2c_f32_bf16_dpp v27, v23, v93 row_newbcast:7 row_mask:0xf bank_mask:0xf
  v_dot2c_f32_bf16_dpp v28, v15, v94 row_newbcast:7 row_mask:0xf bank_mask:0xf
  v_dot2c_f32_bf16_dpp v29, v23, v94 row_newbcast:7 row_mask:0xf bank_mask:0xf
  v_dot2c_f32_bf16_dpp v30, v15, v95 row_newbcast:7 row_mask:0xf bank_mask:0xf
  v_dot2c_f32_bf16_dpp v31, v23, v95 row_newbcast:7 row_mask:0xf bank_mask:0xf
  s_waitcnt vmcnt(4)
  v_dot2c_f32_bf16_dpp v24, v15, v96 row_newbcast:8 row_mask:0xf bank_mask:0xf
  v_dot2c_f32_bf16_dpp v25, v23, v96 row_newbcast:8 row_mask:0xf bank_mask:0xf
  v_dot2c_f32_bf16_dpp v26, v15, v97 row_newbcast:8 row_mask:0xf bank_mask:0xf
  v_dot2c_f32_bf16_dpp v27, v23, v97 row_newbcast:8 row_mask:0xf bank_mask:0xf
  v_dot2c_f32_bf16_dpp v28, v15, v98 row_newbcast:8 row_mask:0xf bank_mask:0xf
  v_dot2c_f32_bf16_dpp v29, v23, v98 row_newbcast:8 row_mask:0xf bank_mask:0xf
  v_dot2c_f32_bf16_dpp v30, v15, v99 row_newbcast:8 row_mask:0xf bank_mask:0xf
  v_dot2c_f32_bf16_dpp v31, v23, v99 row_newbcast:8 row_mask:0xf bank_mask:0xf
  v_dot2c_f32_bf16_dpp v24, v15, v100 row_newbcast:9 row_mask:0xf bank_mask:0xf
  v_dot2c_f32_bf16_dpp v25, v23, v100 row_newbcast:9 row_mask:0xf bank_mask:0xf
  v_dot2c_f32_bf16_dpp v26, v15, v101 row_newbcast:9 row_mask:0xf bank_mask:0xf
  v_dot2c_f32_bf16_dpp v27, v23, v101 row_newbcast:9 row_mask:0xf bank_mask:0xf
  v_dot2c_f32_bf16_dpp v28, v15, v102 row_newbcast:9 row_mask:0xf bank_mask:0xf
  v_dot2c_f32_bf16_dpp v29, v23, v102 row_newbcast:9 row_mask:0xf bank_mask:0xf
  v_dot2c_f32_bf16_dpp v30, v15, v103 row_newbcast:9 row_mask:0xf bank_mask:0xf
  v_dot2c_f32_bf16_dpp v31, v23, v103 row_newbcast:9 row_mask:0xf bank_mask:0xf
  v_dot2c_f32_bf16_dpp v24, v15, v104 row_newbcast:10 row_mask:0xf bank_mask:0xf
  v_dot2c_f32_bf16_dpp v25, v23, v104 row_newbcast:10 row_mask:0xf bank_mask:0xf
  v_dot2c_f32_bf16_dpp v26, v15, v105 row_newbcast:10 row_mask:0xf bank_mask:0xf
  v_dot2c_f32_bf16_dpp v27, v23, v105 row_newbcast:10 row_mask:0xf bank_mask:0xf
  v_dot2c_f32_bf16_dpp v28, v15, v106 row_newbcast:10 row_mask:0xf bank_mask:0xf
  v_dot2c_f32_bf16_dpp v29, v23, v106 row_newbcast:10 row_mask:0xf bank_mask:0xf
  v_dot2c_f32_bf16_dpp v30, v15, v107 row_newbcast:10 row_mask:0xf bank_mask:0xf
  v_dot2c_f32_bf16_dpp v31, v23, v107 row_newbcast:10 row_mask:0xf bank_mask:0xf
  v_dot2c_f32_bf16_dpp v24, v15, v108 row_newbcast:11 row_mask:0xf bank_mask:0xf
  v_dot2c_f32_bf16_dpp v25, v23, v108 row_newbcast:11 row_mask:0xf bank_mask:0xf
  v_dot2c_f32_bf16_dpp v26, v15, v109 row_newbcast:11 row_mask:0xf bank_mask:0xf
  v_dot2c_f32_bf16_dpp v27, v23, v109 row_newbcast:11 row_mask:0xf bank_mask:0xf
  v_dot2c_f32_bf16_dpp v28, v15, v110 row_newbcast:11 row_mask:0xf bank_mask:0xf
  v_dot2c_f32_bf16_dpp v29, v23, v110 row_newbcast:11 row_mask:0xf bank_mask:0xf
  v_dot2c_f32_bf16_dpp v30, v15, v111 row_newbcast:11 row_mask:0xf bank_mask:0xf
  v_dot2c_f32_bf16_dpp v31, v23, v111 row_newbcast:11 row_mask:0xf bank_mask:0xf
  s_waitcnt vmcnt(0)
  v_dot2c_f32_bf16_dpp v24, v15, v112 row_newbcast:12 row_mask:0xf bank_mask:0xf
  v_dot2c_f32_bf16_dpp v25, v23, v112 row_newbcast:12 row_mask:0xf bank_mask:0xf
  v_dot2c_f32_bf16_dpp v26, v15, v113 row_newbcast:12 row_mask:0xf bank_mask:0xf
  v_dot2c_f32_bf16_dpp v27, v23, v113 row_newbcast:12 row_mask:0xf bank_mask:0xf
  v_dot2c_f32_bf16_dpp v28, v15, v114 row_newbcast:12 row_mask:0xf bank_mask:0xf
  v_dot2c_f32_bf16_dpp v29, v23, v114 row_newbcast:12 row_mask:0xf bank_mask:0xf
  v_dot2c_f32_bf16_dpp v30, v15, v115 row_newbcast:12 row_mask:0xf bank_mask:0xf
  v_dot2c_f32_bf16_dpp v31, v23, v115 row_newbcast:12 row_mask:0xf bank_mask:0xf
  v_dot2c_f32_bf16_dpp v24, v15, v116 row_newbcast:13 row_mask:0xf bank_mask:0xf
  v_dot2c_f32_bf16_dpp v25, v23, v116 row_newbcast:13 row_mask:0xf bank_mask:0xf
  v_dot2c_f32_bf16_dpp v26, v15, v117 row_newbcast:13 row_mask:0xf bank_mask:0xf
  v_dot2c_f32_bf16_dpp v27, v23, v117 row_newbcast:13 row_mask:0xf bank_mask:0xf
  v_dot2c_f32_bf16_dpp v28, v15, v118 row_newbcast:13 row_mask:0xf bank_mask:0xf
  v_dot2c_f32_bf16_dpp v29, v23, v118 row_newbcast:13 row_mask:0xf bank_mask:0xf
  v_dot2c_f32_bf16_dpp v30, v15, v119 row_newbcast:13 row_mask:0xf bank_mask:0xf
  v_dot2c_f32_bf16_dpp v31, v23, v119 row_newbcast:13 row_mask:0xf bank_mask:0xf
  v_dot2c_f32_bf16_dpp v24, v15, v120 row_newbcast:14 row_mask:0xf bank_mask:0xf
  v_dot2c_f32_bf16_dpp v25, v23, v120 row_newbcast:14 row_mask:0xf bank_mask:0xf
  v_dot2c_f32_bf16_dpp v26, v15, v121 row_newbcast:14 row_mask:0xf bank_mask:0xf
  v_dot2c_f32_bf16_dpp v27, v23, v121 row_newbcast:14 row_mask:0xf bank_mask:0xf
  v_dot2c_f32_bf16_dpp v28, v15, v122 row_newbcast:14 row_mask:0xf bank_mask:0xf
  v_dot2c_f32_bf16_dpp v29, v23, v122 row_newbcast:14 row_mask:0xf bank_mask:0xf
  v_dot2c_f32_bf16_dpp v30, v15, v123 row_newbcast:14 row_mask:0xf bank_mask:0xf
  v_dot2c_f32_bf16_dpp v31, v23, v123 row_newbcast:14 row_mask:0xf bank_mask:0xf
  v_dot2c_f32_bf16_dpp v24, v15, v124 row_newbcast:15 row_mask:0xf bank_mask:0xf
  v_dot2c_f32_bf16_dpp v25, v23, v124 row_newbcast:15 row_mask:0xf bank_mask:0xf
  v_dot2c_f32_bf16_dpp v26, v15, v125 row_newbcast:15 row_mask:0xf bank_mask:0xf
  v_dot2c_f32_bf16_dpp v27, v23, v125 row_newbcast:15 row_mask:0xf bank_mask:0xf
  v_dot2c_f32_bf16_dpp v28, v15, v126 row_newbcast:15 row_mask:0xf bank_mask:0xf
  v_dot2c_f32_bf16_dpp v29, v23, v126 row_newbcast:15 row_mask:0xf bank_mask:0xf
  v_dot2c_f32_bf16_dpp v30, v15, v127 row_newbcast:15 row_mask:0xf bank_mask:0xf
  v_dot2c_f32_bf16_dpp v31, v23, v127 row_newbcast:15 row_mask:0xf bank_mask:0xf
  s_nop 2
  v_mov_b32 v8, v24
  v_mov_b32 v9, v25
  v_mov_b32 v10, v26
  v_mov_b32 v11, v27
  v_mov_b32 v12, v28
  v_mov_b32 v13, v29
  v_mov_b32 v14, v30
  v_mov_b32 v15, v31
  s_nop 1
  v_permlane32_swap_b32 v8, v24
  v_permlane32_swap_b32 v9, v25
  v_permlane32_swap_b32 v10, v26
  v_permlane32_swap_b32 v11, v27
  v_permlane32_swap_b32 v12, v28
  v_permlane32_swap_b32 v13, v29
  v_permlane32_swap_b32 v14, v30
  v_permlane32_swap_b32 v15, v31
  v_add_f32 v24, v8, v24
  v_add_f32 v25, v9, v25
  v_add_f32 v26, v10, v26
  v_add_f32 v27, v11, v27
  v_add_f32 v28, v12, v28
  v_add_f32 v29, v13, v29
  v_add_f32 v30, v14, v30
  v_add_f32 v31, v15, v31
  v_mov_b32 v8, v24
  v_mov_b32 v9, v25
  v_mov_b32 v10, v26
  v_mov_b32 v11, v27
  v_mov_b32 v12, v28
  v_mov_b32 v13, v29
  v_mov_b32 v14, v30
  v_mov_b32 v15, v31
  s_nop 1
  v_permlane16_swap_b32 v8, v24
  v_permlane16_swap_b32 v9, v25
  v_permlane16_swap_b32 v10, v26
  v_permlane16_swap_b32 v11, v27
  v_permlane16_swap_b32 v12, v28
  v_permlane16_swap_b32 v13, v29
  v_permlane16_swap_b32 v14, v30
  v_permlane16_swap_b32 v15, v31
  v_add_f32 v24, v8, v24
  v_add_f32 v25, v9, v25
  v_add_f32 v26, v10, v26
  v_add_f32 v27, v11, v27
  v_add_f32 v28, v12, v28
  v_add_f32 v29, v13, v29
  v_add_f32 v30, v14, v30
  v_add_f32 v31, v15, v31
  s_lshl_b32 s56, s20, 9
  v_lshlrev_b32 v7, 5, v2
  v_add_u32 v6, s56, v7
  ds_write_b128 v6, v[24:27] offset:10240
  ds_write_b128 v6, v[28:31] offset:10256
  v_mov_b32 v10, 0
  buffer_load_dword v11, v10, s[48:51], 0 offen offset:128 sc1
  v_lshrrev_b32 v6, 3, v1
  v_and_b32 v7, 7, v1
  s_lshl_b32 s56, s20, 5
  v_lshlrev_b32 v6, 9, v6
  v_lshl_add_u32 v6, v7, 2, v6
  v_add_u32 v6, s56, v6
  s_waitcnt lgkmcnt(0)
  s_barrier
  ds_read_b32 v8, v6 offset:10240
  ds_read_b32 v9, v6 offset:14336
  s_waitcnt lgkmcnt(0)
  v_add_f32 v8, v8, v9
  s_nop 1
  v_add_f32_dpp v8, v8, v8 row_ror:8 row_mask:0xf bank_mask:0xf
  v_mov_b32 v9, v8
  s_nop 1
  v_permlane32_swap_b32 v9, v8
  v_add_f32 v8, v9, v8
  v_mov_b32 v9, v8
  s_nop 1
  v_permlane16_swap_b32 v9, v8
  v_add_f32 v8, v9, v8
  v_cvt_pk_bf16_f32 v8, v8, v8
  v_and_b32 v8, 0xffff0000, v8
  s_nop 0
  v_readlane_b32 s72, v8, 0
  v_readlane_b32 s73, v8, 1
  v_readlane_b32 s74, v8, 2
  v_readlane_b32 s75, v8, 3
  v_readlane_b32 s76, v8, 4
  v_readlane_b32 s77, v8, 5
  v_readlane_b32 s78, v8, 6
  v_readlane_b32 s79, v8, 7
  s_nop 0
  s_lshr_b32 s64, s72, 16
  s_lshr_b32 s65, s73, 16
  s_lshr_b32 s66, s74, 16
  s_lshr_b32 s67, s75, 16
  s_lshr_b32 s68, s76, 16
  s_lshr_b32 s69, s77, 16
  s_lshr_b32 s70, s78, 16
  s_lshr_b32 s71, s79, 16
  v_mov_b32 v24, 0
  v_mov_b32 v25, 0
  v_mov_b32 v26, 0
  v_mov_b32 v27, 0
  v_mov_b32 v28, 0
  v_mov_b32 v29, 0
  v_mov_b32 v30, 0
  v_mov_b32 v31, 0
  s_waitcnt vmcnt(0)
  v_dot2c_f32_bf16 v24, s64, v32
  v_dot2c_f32_bf16 v25, s72, v32
  v_dot2c_f32_bf16 v26, s64, v33
  v_dot2c_f32_bf16 v27, s72, v33
  v_dot2c_f32_bf16 v28, s64, v34
  v_dot2c_f32_bf16 v29, s72, v34
  v_dot2c_f32_bf16 v30, s64, v35
  v_dot2c_f32_bf16 v31, s72, v35
  v_dot2c_f32_bf16 v24, s65, v36
  v_dot2c_f32_bf16 v25, s73, v36
  v_dot2c_f32_bf16 v26, s65, v37
  v_dot2c_f32_bf16 v27, s73, v37
  v_dot2c_f32_bf16 v28, s65, v38
  v_dot2c_f32_bf16 v29, s73, v38
  v_dot2c_f32_bf16 v30, s65, v39
  v_dot2c_f32_bf16 v31, s73, v39
  v_dot2c_f32_bf16 v24, s66, v40
  v_dot2c_f32_bf16 v25, s74, v40
  v_dot2c_f32_bf16 v26, s66, v41
  v_dot2c_f32_bf16 v27, s74, v41
  v_dot2c_f32_bf16 v28, s66, v42
  v_dot2c_f32_bf16 v29, s74, v42
  v_dot2c_f32_bf16 v30, s66, v43
  v_dot2c_f32_bf16 v31, s74, v43
  v_dot2c_f32_bf16 v24, s67, v44
  v_dot2c_f32_bf16 v25, s75, v44
  v_dot2c_f32_bf16 v26, s67, v45
  v_dot2c_f32_bf16 v27, s75, v45
  v_dot2c_f32_bf16 v28, s67, v46
  v_dot2c_f32_bf16 v29, s75, v46
  v_dot2c_f32_bf16 v30, s67, v47
  v_dot2c_f32_bf16 v31, s75, v47
  v_dot2c_f32_bf16 v24, s68, v48
  v_dot2c_f32_bf16 v25, s76, v48
  v_dot2c_f32_bf16 v26, s68, v49
  v_dot2c_f32_bf16 v27, s76, v49
  v_dot2c_f32_bf16 v28, s68, v50
  v_dot2c_f32_bf16 v29, s76, v50
  v_dot2c_f32_bf16 v30, s68, v51
  v_dot2c_f32_bf16 v31, s76, v51
  v_dot2c_f32_bf16 v24, s69, v52
  v_dot2c_f32_bf16 v25, s77, v52
  v_dot2c_f32_bf16 v26, s69, v53
  v_dot2c_f32_bf16 v27, s77, v53
  v_dot2c_f32_bf16 v28, s69, v54
  v_dot2c_f32_bf16 v29, s77, v54
  v_dot2c_f32_bf16 v30, s69, v55
  v_dot2c_f32_bf16 v31, s77, v55
  v_dot2c_f32_bf16 v24, s70, v56
  v_dot2c_f32_bf16 v25, s78, v56
  v_dot2c_f32_bf16 v26, s70, v57
  v_dot2c_f32_bf16 v27, s78, v57
  v_dot2c_f32_bf16 v28, s70, v58
  v_dot2c_f32_bf16 v29, s78, v58
  v_dot2c_f32_bf16 v30, s70, v59
  v_dot2c_f32_bf16 v31, s78, v59
  v_dot2c_f32_bf16 v24, s71, v60
  v_dot2c_f32_bf16 v25, s79, v60
  v_dot2c_f32_bf16 v26, s71, v61
  v_dot2c_f32_bf16 v27, s79, v61
  v_dot2c_f32_bf16 v28, s71, v62
  v_dot2c_f32_bf16 v29, s79, v62
  v_dot2c_f32_bf16 v30, s71, v63
  v_dot2c_f32_bf16 v31, s79, v63
  s_lshl_b32 s56, s20, 11
  v_lshlrev_b32 v6, 5, v1
  v_add_u32 v6, s56, v6
  s_nop 1
  ds_write_b128 v6, v[24:27] offset:18432
  ds_write_b128 v6, v[28:31] offset:18448
  v_and_b32 v6, 511, v0
  v_lshlrev_b32 v6, 2, v6
L_zpoll:
  v_readfirstlane_b32 s56, v11
  s_cmp_lg_u32 s56, 0
  s_cbranch_scc1 L_zok
  s_sleep 2
  buffer_load_dword v11, v10, s[48:51], 0 offen offset:128 sc1
  s_waitcnt vmcnt(0)
  s_branch L_zpoll
L_zok:
  s_waitcnt lgkmcnt(0)
  s_barrier
  s_cmp_ge_u32 s20, 8
  s_cbranch_scc1 L_skipred
  ds_read_b32 v8, v6 offset:18432
  ds_read_b32 v9, v6 offset:20480
  ds_read_b32 v10, v6 offset:22528
  ds_read_b32 v11, v6 offset:24576
  ds_read_b32 v12, v6 offset:26624
  ds_read_b32 v13, v6 offset:28672
  ds_read_b32 v14, v6 offset:30720
  ds_read_b32 v15, v6 offset:32768
  ds_read_b32 v16, v6 offset:34816
  ds_read_b32 v17, v6 offset:36864
  ds_read_b32 v18, v6 offset:38912
  ds_read_b32 v19, v6 offset:40960
  ds_read_b32 v20, v6 offset:43008
  ds_read_b32 v21, v6 offset:45056
  ds_read_b32 v22, v6 offset:47104
  ds_read_b32 v23, v6 offset:49152
  s_waitcnt lgkmcnt(0)
  v_add_f32 v8, v8, v16
  v_add_f32 v9, v9, v17
  v_add_f32 v10, v10, v18
  v_add_f32 v11, v11, v19
  v_add_f32 v12, v12, v20
  v_add_f32 v13, v13, v21
  v_add_f32 v14, v14, v22
  v_add_f32 v15, v15, v23
  v_add_f32 v8, v8, v12
  v_add_f32 v9, v9, v13
  v_add_f32 v10, v10, v14
  v_add_f32 v11, v11, v15
  v_add_f32 v8, v8, v9
  v_add_f32 v10, v10, v11
  v_add_f32 v8, v8, v10
  s_lshl_b32 s56, s22, 11
  s_add_u32 s56, s56, 0
  buffer_atomic_add_f32 v8, v6, s[44:47], s56 offen
L_skipred:
  s_waitcnt vmcnt(0)
  s_barrier
  s_cmp_lg_u32 s20, 0
  s_cbranch_scc1 L_tk
  v_mov_b32 v8, 1
  v_mov_b32 v10, 1
  v_mov_b32 v9, 0
  s_mov_b64 s[62:63], exec
  s_mov_b64 exec, 1
  buffer_atomic_add v10, v9, s[48:51], 0 offen offset:0
  buffer_atomic_add v8, v9, s[48:51], 0 offen offset:64 sc0
  s_waitcnt vmcnt(0)
  ds_write_b32 v9, v8 offset:9344
  s_mov_b64 exec, s[62:63]
  s_waitcnt lgkmcnt(0)
L_tk:
  s_barrier
  v_mov_b32 v9, 0
  ds_read_b32 v8, v9 offset:9344
  s_waitcnt lgkmcnt(0)
  v_readfirstlane_b32 s3, v8
  s_cmp_ge_u32 s3, 43
  s_cbranch_scc1 L_end
  s_barrier
  s_load_dwordx4 s[8:11], s[0:1], 48
  s_load_dwordx4 s[12:15], s[0:1], 64
  v_lshlrev_b32 v10, 4, v0
  v_lshrrev_b32 v6, 2, v0
  s_movk_i32 s57, 2752
  v_mul_lo_u32 v6, v6, s57
  v_and_b32 v7, 3, v0
  s_lshl_b32 s56, s3, 6
  v_lshl_add_u32 v6, v7, 4, v6
  v_add_u32 v6, s56, v6
  v_add_u32 v7, 50176, v10
  v_add_u32 v8, 82944, v10
  v_add_u32 v9, 115712, v10
  s_waitcnt lgkmcnt(0)
  s_mov_b32 s24, s8
  s_and_b32 s25, s9, 0xffff
  s_mov_b32 s26, 1409024
  s_mov_b32 s27, 0x00020000
  s_mov_b32 s52, s10
  s_and_b32 s53, s11, 0xffff
  s_mov_b32 s54, 1409024
  s_mov_b32 s55, 0x00020000
  s_mov_b32 s28, s12
  s_and_b32 s29, s13, 0xffff
  s_mov_b32 s30, 1409024
  s_mov_b32 s31, 0x00020000
  s_mov_b32 s32, s14
  s_and_b32 s33, s15, 0xffff
  s_mov_b32 s34, 8192
  s_mov_b32 s35, 0x00020000
  s_mov_b32 s36, s4
  s_and_b32 s37, s5, 0xffff
  s_mov_b32 s38, 8192
  s_mov_b32 s39, 0x00020000
  s_mov_b32 s57, 704512
  s_lshl_b32 s58, s3, 15
  s_add_u32 s59, s58, 16384
  buffer_load_dwordx4 v[16:19], v6, s[24:27], 0 offen
  buffer_load_dwordx4 v[20:23], v6, s[24:27], s57 offen
  buffer_load_dwordx4 v[24:27], v6, s[52:55], 0 offen
  buffer_load_dwordx4 v[28:31], v6, s[52:55], s57 offen
  buffer_load_dwordx4 v[32:35], v10, s[28:31], s58 offen
  buffer_load_dwordx4 v[36:39], v10, s[28:31], s59 offen
  buffer_load_dwordx4 v[12:15], v10, s[36:39], 0 offen
  s_lshr_b32 s21, s20, 3
  s_bfe_u32 s22, s20, 0x10002
  s_and_b32 s23, s20, 3
  v_lshrrev_b32 v2, 4, v1
  v_bfe_u32 v3, v1, 2, 2
  v_and_b32 v4, 3, v1
  v_and_b32 v11, 7, v1
  v_lshlrev_b32 v40, 10, v11
  v_lshl_add_u32 v40, v2, 4, v40
  s_lshl_b32 s56, s23, 8
  v_add_u32 v40, s56, v40
  v_lshl_add_u32 v41, v2, 3, v3
  v_lshlrev_b32 v42, 6, v41
  v_lshl_add_u32 v42, v4, 3, v42
  s_lshl_b32 s56, s23, 13
  s_lshl_b32 s57, s22, 5
  s_add_u32 s56, s56, s57
  s_mul_i32 s57, s21, 32768
  s_add_u32 s56, s56, s57
  s_add_u32 s56, s56, 50176
  v_add_u32 v42, s56, v42
  v_lshlrev_b32 v43, 10, v41
  v_lshl_add_u32 v43, v4, 3, v43
  s_lshl_b32 s56, s20, 6
  s_add_u32 s56, s56, 115712
  v_add_u32 v43, s56, v43
  v_lshlrev_b32 v44, 6, v11
  v_lshl_add_u32 v44, v2, 4, v44
  v_and_b32 v45, 15, v1
  v_lshlrev_b32 v46, 9, v2
  v_lshl_add_u32 v46, v45, 2, v46
  s_lshl_b32 s56, s23, 1
  s_add_u32 s56, s56, s21
  s_lshl_b32 s56, s56, 10
  s_lshl_b32 s57, s22, 6
  s_add_u32 s56, s56, s57
  v_add_u32 v46, s56, v46
  v_lshlrev_b32 v47, 13, v2
  v_lshl_add_u32 v47, v45, 2, v47
  s_lshl_b32 s56, s20, 7
  v_add_u32 v47, s56, v47
  s_waitcnt vmcnt(1)
  ds_write_b128 v7, v[16:19]
  ds_write_b128 v7, v[20:23] offset:16384
  ds_write_b128 v8, v[24:27]
  ds_write_b128 v8, v[28:31] offset:16384
  ds_write_b128 v9, v[32:35]
  ds_write_b128 v9, v[36:39] offset:16384
  s_cmp_lg_u32 s20, 0
  s_cbranch_scc1 L_polled
  v_mov_b32 v16, 0
L_poll:
  buffer_load_dword v17, v16, s[48:51], 0 offen offset:0 sc1
  s_waitcnt vmcnt(0)
  v_readfirstlane_b32 s56, v17
  s_cmp_ge_u32 s56, 256
  s_cbranch_scc1 L_polled
  s_sleep 8
  s_branch L_poll
L_polled:
  s_barrier
  s_cmp_ge_u32 s20, 8
  s_cbranch_scc1 L_noln
  v_lshlrev_b32 v11, 5, v0
  buffer_load_dwordx4 v[16:19], v11, s[44:47], 0 offen offset:0 sc1
  buffer_load_dwordx4 v[20:23], v11, s[44:47], 0 offen offset:16 sc1
  s_waitcnt vmcnt(0)
  v_lshlrev_b32 v24, 16, v12
  v_and_b32 v25, 0xffff0000, v12
  v_lshlrev_b32 v26, 16, v13
  v_and_b32 v27, 0xffff0000, v13
  v_lshlrev_b32 v28, 16, v14
  v_and_b32 v29, 0xffff0000, v14
  v_lshlrev_b32 v30, 16, v15
  v_and_b32 v31, 0xffff0000, v15
  v_cvt_pk_bf16_f32 v16, v16, v16
  v_and_b32 v16, 0xffff0000, v16
  v_add_f32 v24, v24, v16
  v_cvt_pk_bf16_f32 v24, v24, v24
  v_and_b32 v24, 0xffff0000, v24
  v_cvt_pk_bf16_f32 v17, v17, v17
  v_and_b32 v17, 0xffff0000, v17
  v_add_f32 v25, v25, v17
  v_cvt_pk_bf16_f32 v25, v25, v25
  v_and_b32 v25, 0xffff0000, v25
  v_cvt_pk_bf16_f32 v18, v18, v18
  v_and_b32 v18, 0xffff0000, v18
  v_add_f32 v26, v26, v18
  v_cvt_pk_bf16_f32 v26, v26, v26
  v_and_b32 v26, 0xffff0000, v26
  v_cvt_pk_bf16_f32 v19, v19, v19
  v_and_b32 v19, 0xffff0000, v19
  v_add_f32 v27, v27, v19
  v_cvt_pk_bf16_f32 v27, v27, v27
  v_and_b32 v27, 0xffff0000, v27
  v_cvt_pk_bf16_f32 v20, v20, v20
  v_and_b32 v20, 0xffff0000, v20
  v_add_f32 v28, v28, v20
  v_cvt_pk_bf16_f32 v28, v28, v28
  v_and_b32 v28, 0xffff0000, v28
  v_cvt_pk_bf16_f32 v21, v21, v21
  v_and_b32 v21, 0xffff0000, v21
  v_add_f32 v29, v29, v21
  v_cvt_pk_bf16_f32 v29, v29, v29
  v_and_b32 v29, 0xffff0000, v29
  v_cvt_pk_bf16_f32 v22, v22, v22
  v_and_b32 v22, 0xffff0000, v22
  v_add_f32 v30, v30, v22
  v_cvt_pk_bf16_f32 v30, v30, v30
  v_and_b32 v30, 0xffff0000, v30
  v_cvt_pk_bf16_f32 v23, v23, v23
  v_and_b32 v23, 0xffff0000, v23
  v_add_f32 v31, v31, v23
  v_cvt_pk_bf16_f32 v31, v31, v31
  v_and_b32 v31, 0xffff0000, v31
  ds_write_b128 v11, v[24:27] offset:33792
  ds_write_b128 v11, v[28:31] offset:33808
  v_add_f32 v32, v24, v25
  v_add_f32 v33, v26, v27
  v_add_f32 v34, v28, v29
  v_add_f32 v35, v30, v31
  v_add_f32 v32, v32, v33
  v_add_f32 v34, v34, v35
  v_add_f32 v32, v32, v34
  s_nop 1
  v_add_f32_dpp v32, v32, v32 row_ror:8 row_mask:0xf bank_mask:0xf
  s_nop 1
  v_add_f32_dpp v32, v32, v32 row_ror:4 row_mask:0xf bank_mask:0xf
  s_nop 1
  v_add_f32_dpp v32, v32, v32 row_ror:2 row_mask:0xf bank_mask:0xf
  s_nop 1
  v_add_f32_dpp v32, v32, v32 row_ror:1 row_mask:0xf bank_mask:0xf
  s_nop 1
  v_add_f32_dpp v32, v32, v32 row_bcast:15 row_mask:0xa bank_mask:0xf
  s_nop 1
  v_add_f32_dpp v32, v32, v32 row_bcast:31 row_mask:0xc bank_mask:0xf
  s_nop 0
  v_readlane_b32 s60, v32, 63
  s_nop 1
  v_mov_b32 v36, s60
  v_mul_f32 v36, 0x3b000000, v36
  v_sub_f32 v32, v24, v36
  v_mul_f32 v33, v32, v32
  v_sub_f32 v32, v25, v36
  v_fmac_f32 v33, v32, v32
  v_sub_f32 v32, v26, v36
  v_fmac_f32 v33, v32, v32
  v_sub_f32 v32, v27, v36
  v_fmac_f32 v33, v32, v32
  v_sub_f32 v32, v28, v36
  v_fmac_f32 v33, v32, v32
  v_sub_f32 v32, v29, v36
  v_fmac_f32 v33, v32, v32
  v_sub_f32 v32, v30, v36
  v_fmac_f32 v33, v32, v32
  v_sub_f32 v32, v31, v36
  v_fmac_f32 v33, v32, v32
  s_nop 1
  v_add_f32_dpp v33, v33, v33 row_ror:8 row_mask:0xf bank_mask:0xf
  s_nop 1
  v_add_f32_dpp v33, v33, v33 row_ror:4 row_mask:0xf bank_mask:0xf
  s_nop 1
  v_add_f32_dpp v33, v33, v33 row_ror:2 row_mask:0xf bank_mask:0xf
  s_nop 1
  v_add_f32_dpp v33, v33, v33 row_ror:1 row_mask:0xf bank_mask:0xf
  s_nop 1
  v_add_f32_dpp v33, v33, v33 row_bcast:15 row_mask:0xa bank_mask:0xf
  s_nop 1
  v_add_f32_dpp v33, v33, v33 row_bcast:31 row_mask:0xc bank_mask:0xf
  s_nop 0
  v_readlane_b32 s61, v33, 63
  s_nop 1
  v_mov_b32 v33, s61
  v_mul_f32 v33, 0x3b000000, v33
  v_cvt_pk_bf16_f32 v33, v33, v33
  v_and_b32 v33, 0xffff0000, v33
  v_add_f32 v33, 0x3727c5ac, v33
  v_cvt_pk_bf16_f32 v33, v33, v33
  v_and_b32 v33, 0xffff0000, v33
  v_sqrt_f32 v33, v33
  s_nop 0
  v_cvt_pk_bf16_f32 v33, v33, v33
  v_and_b32 v33, 0xffff0000, v33
  v_rcp_f32 v34, v33
  v_cvt_pk_bf16_f32 v36, v36, v36
  v_and_b32 v36, 0xffff0000, v36
  v_sub_f32 v32, v24, v36
  v_cvt_pk_bf16_f32 v32, v32, v32
  v_and_b32 v32, 0xffff0000, v32
  v_mul_f32 v35, v32, v34
  v_fma_f32 v32, -v35, v33, v32
  v_fma_f32 v24, v32, v34, v35
  v_sub_f32 v32, v25, v36
  v_cvt_pk_bf16_f32 v32, v32, v32
  v_and_b32 v32, 0xffff0000, v32
  v_mul_f32 v35, v32, v34
  v_fma_f32 v32, -v35, v33, v32
  v_fma_f32 v25, v32, v34, v35
  v_sub_f32 v32, v26, v36
  v_cvt_pk_bf16_f32 v32, v32, v32
  v_and_b32 v32, 0xffff0000, v32
  v_mul_f32 v35, v32, v34
  v_fma_f32 v32, -v35, v33, v32
  v_fma_f32 v26, v32, v34, v35
  v_sub_f32 v32, v27, v36
  v_cvt_pk_bf16_f32 v32, v32, v32
  v_and_b32 v32, 0xffff0000, v32
  v_mul_f32 v35, v32, v34
  v_fma_f32 v32, -v35, v33, v32
  v_fma_f32 v27, v32, v34, v35
  v_sub_f32 v32, v28, v36
  v_cvt_pk_bf16_f32 v32, v32, v32
  v_and_b32 v32, 0xffff0000, v32
  v_mul_f32 v35, v32, v34
  v_fma_f32 v32, -v35, v33, v32
  v_fma_f32 v28, v32, v34, v35
  v_sub_f32 v32, v29, v36
  v_cvt_pk_bf16_f32 v32, v32, v32
  v_and_b32 v32, 0xffff0000, v32
  v_mul_f32 v35, v32, v34
  v_fma_f32 v32, -v35, v33, v32
  v_fma_f32 v29, v32, v34, v35
  v_sub_f32 v32, v30, v36
  v_cvt_pk_bf16_f32 v32, v32, v32
  v_and_b32 v32, 0xffff0000, v32
  v_mul_f32 v35, v32, v34
  v_fma_f32 v32, -v35, v33, v32
  v_fma_f32 v30, v32, v34, v35
  v_sub_f32 v32, v31, v36
  v_cvt_pk_bf16_f32 v32, v32, v32
  v_and_b32 v32, 0xffff0000, v32
  v_mul_f32 v35, v32, v34
  v_fma_f32 v32, -v35, v33, v32
  v_fma_f32 v31, v32, v34, v35
  v_cvt_pk_bf16_f32 v12, v24, v25
  v_cvt_pk_bf16_f32 v13, v26, v27
  v_cvt_pk_bf16_f32 v14, v28, v29
  v_cvt_pk_bf16_f32 v15, v30, v31
  ds_write_b128 v10, v[12:15] offset:0
L_noln:
  s_waitcnt vmcnt(0) lgkmcnt(0)
  s_barrier
  ds_read_b128 v[48:51], v40 offset:0
  ds_read_b64_tr_b16 v[64:65], v42 offset:0
  ds_read_b64_tr_b16 v[66:67], v42 offset:256
  ds_read_b128 v[52:55], v40 offset:64
  ds_read_b64_tr_b16 v[68:69], v42 offset:2048
  ds_read_b64_tr_b16 v[70:71], v42 offset:2304
  ds_read_b128 v[56:59], v40 offset:128
  ds_read_b64_tr_b16 v[72:73], v42 offset:4096
  ds_read_b64_tr_b16 v[74:75], v42 offset:4352
  ds_read_b128 v[60:63], v40 offset:192
  ds_read_b64_tr_b16 v[76:77], v42 offset:6144
  ds_read_b64_tr_b16 v[78:79], v42 offset:6400
  s_waitcnt lgkmcnt(9)
  v_mfma_f32_16x16x32_bf16 v[80:83], v[48:51], v[64:67], 0
  s_waitcnt lgkmcnt(6)
  v_mfma_f32_16x16x32_bf16 v[80:83], v[52:55], v[68:71], v[80:83]
  s_waitcnt lgkmcnt(3)
  v_mfma_f32_16x16x32_bf16 v[80:83], v[56:59], v[72:75], v[80:83]
  s_waitcnt lgkmcnt(0)
  v_mfma_f32_16x16x32_bf16 v[80:83], v[60:63], v[76:79], v[80:83]
  s_nop 7
  s_nop 3
  s_mov_b32 exec_hi, 0
  ds_write_b32 v46, v80 offset:8192
  ds_write_b32 v46, v81 offset:8320
  ds_write_b32 v46, v82 offset:8448
  ds_write_b32 v46, v83 offset:8576
  s_mov_b32 exec_hi, -1
  v_lshlrev_b32 v12, 2, v0
  s_waitcnt lgkmcnt(0)
  s_barrier
  s_cmp_ge_u32 s20, 4
  s_cbranch_scc1 L_noact
  ds_read_b32 v16, v12 offset:8192
  ds_read_b32 v20, v12 offset:9216
  ds_read_b32 v17, v12 offset:10240
  ds_read_b32 v21, v12 offset:11264
  ds_read_b32 v18, v12 offset:12288
  ds_read_b32 v22, v12 offset:13312
  ds_read_b32 v19, v12 offset:14336
  ds_read_b32 v23, v12 offset:15360
  s_waitcnt lgkmcnt(0)
  v_add_f32 v16, v16, v17
  v_add_f32 v18, v18, v19
  v_add_f32 v16, v16, v18
  v_cvt_pk_bf16_f32 v16, v16, v16
  v_and_b32 v16, 0xffff0000, v16
  v_add_f32 v20, v20, v21
  v_add_f32 v22, v22, v23
  v_add_f32 v20, v20, v22
  v_cvt_pk_bf16_f32 v20, v20, v20
  v_and_b32 v20, 0xffff0000, v20
  v_mul_f32 v17, 0xbfb8aa3b, v16
  v_exp_f32 v17, v17
  s_nop 0
  v_add_f32 v17, 1.0, v17
  v_rcp_f32 v18, v17
  s_nop 0
  v_mul_f32 v19, v16, v18
  v_fma_f32 v21, -v19, v17, v16
  v_fma_f32 v19, v21, v18, v19
  v_mul_f32 v22, v16, v18
  v_cmp_u_f32 vcc, v19, v19
  s_nop 1
  v_cndmask_b32 v19, v19, v22, vcc
  v_cvt_pk_bf16_f32 v19, v19, v19
  v_and_b32 v19, 0xffff0000, v19
  v_mul_f32 v19, v19, v20
  v_cvt_pk_bf16_f32 v19, v19, v19
  v_lshrrev_b32 v13, 1, v12
  ds_write_b16 v13, v19 offset:16384
  s_waitcnt lgkmcnt(0)
L_noact:
  s_barrier
  ds_read_b128 v[48:51], v44 offset:16384
  ds_read_b64_tr_b16 v[64:65], v43 offset:0
  ds_read_b64_tr_b16 v[66:67], v43 offset:4096
  ds_read_b64_tr_b16 v[68:69], v43 offset:32
  ds_read_b64_tr_b16 v[70:71], v43 offset:4128
  s_waitcnt lgkmcnt(0)
  v_mfma_f32_16x16x32_bf16 v[80:83], v[48:51], v[64:67], 0
  v_mfma_f32_16x16x32_bf16 v[84:87], v[48:51], v[68:71], 0
  s_nop 7
  s_nop 3
  s_mov_b32 exec_hi, 0
  ds_write_b32 v47, v80 offset:17408
  ds_write_b32 v47, v81 offset:19456
  ds_write_b32 v47, v82 offset:21504
  ds_write_b32 v47, v83 offset:23552
  ds_write_b32 v47, v84 offset:17472
  ds_write_b32 v47, v85 offset:19520
  ds_write_b32 v47, v86 offset:21568
  ds_write_b32 v47, v87 offset:23616
  s_mov_b32 exec_hi, -1
  s_waitcnt lgkmcnt(0)
  s_barrier
  ds_read_b32 v16, v12 offset:17408
  ds_read_b32 v17, v12 offset:21504
  ds_read_b32 v18, v12 offset:25600
  ds_read_b32 v19, v12 offset:29696
  s_mov_b32 s56, 16384
  s_waitcnt lgkmcnt(3)
  buffer_atomic_add_f32 v16, v12, s[44:47], s56 offen
  s_waitcnt lgkmcnt(2)
  s_add_u32 s56, s56, 4096
  buffer_atomic_add_f32 v17, v12, s[44:47], s56 offen
  s_waitcnt lgkmcnt(1)
  s_add_u32 s56, s56, 4096
  buffer_atomic_add_f32 v18, v12, s[44:47], s56 offen
  s_waitcnt lgkmcnt(0)
  s_add_u32 s56, s56, 4096
  buffer_atomic_add_f32 v19, v12, s[44:47], s56 offen
  s_waitcnt vmcnt(0)
  s_barrier
  s_cmp_lg_u32 s20, 0
  s_cbranch_scc1 L_wait_flag
  v_mov_b32 v8, 1
  v_mov_b32 v9, 0
  s_mov_b64 s[62:63], exec
  s_mov_b64 exec, 1
  buffer_atomic_add v8, v9, s[48:51], 0 offen offset:192 sc0
  s_waitcnt vmcnt(0)
  ds_write_b32 v9, v8 offset:16896
  s_mov_b64 exec, s[62:63]
  s_waitcnt lgkmcnt(0)
L_wait_flag:
  s_barrier
  v_mov_b32 v9, 0
  ds_read_b32 v8, v9 offset:16896
  s_waitcnt lgkmcnt(0)
  v_readfirstlane_b32 s56, v8
  s_cmp_lg_u32 s56, 42
  s_cbranch_scc1 L_end
  s_mov_b32 s56, 16384
  buffer_load_dwordx4 v[12:15], v10, s[44:47], s56 offen sc1
  ds_read_b128 v[16:19], v10 offset:33792
  v_lshlrev_b32 v11, 3, v0
  s_waitcnt vmcnt(0) lgkmcnt(0)
  v_cvt_pk_bf16_f32 v12, v12, v12
  v_and_b32 v12, 0xffff0000, v12
  v_add_f32 v12, v12, v16
  v_cvt_pk_bf16_f32 v13, v13, v13
  v_and_b32 v13, 0xffff0000, v13
  v_add_f32 v13, v13, v17
  v_cvt_pk_bf16_f32 v14, v14, v14
  v_and_b32 v14, 0xffff0000, v14
  v_add_f32 v14, v14, v18
  v_cvt_pk_bf16_f32 v15, v15, v15
  v_and_b32 v15, 0xffff0000, v15
  v_add_f32 v15, v15, v19
  v_cvt_pk_bf16_f32 v20, v12, v13
  v_cvt_pk_bf16_f32 v21, v14, v15
  buffer_store_dwordx2 v[20:21], v11, s[32:35], 0 offen
L_end:
  s_endpgm
.section .rodata,"a"
.p2align 6
.amdhsa_kernel sequential_preLN__mha_block_cached__swiglu_ffn__decode_kernel
  .amdhsa_next_free_vgpr 128
  .amdhsa_next_free_sgpr 102
  .amdhsa_accum_offset 128
  .amdhsa_group_segment_fixed_size 0
  .amdhsa_kernarg_size 96
  .amdhsa_user_sgpr_count 2
  .amdhsa_user_sgpr_kernarg_segment_ptr 1
  .amdhsa_system_sgpr_workgroup_id_x 1
.end_amdhsa_kernel
```
